```python
import torch

def _softmax(x, axis=-1):
    return torch.softmax(x, dim=axis)
def _gelu(x):
    return torch.nn.functional.gelu(x, approximate="tanh")
def _silu(x):
    return torch.nn.functional.silu(x)
def _sigmoid(x):
    return torch.sigmoid(x)
def _layernorm(x, axis=-1, eps=1e-5):
    m = x.mean(dim=axis, keepdim=True)
    v = x.var(dim=axis, keepdim=True, unbiased=False)
    return (x - m) / torch.sqrt(v + eps)
def _scatter_add(tgt, idx, src, axis=0):
    return tgt.clone().index_add_(axis, idx, src)
def _segment_sum(src, seg, n):
    out = torch.zeros((n,) + src.shape[1:], dtype=src.dtype)
    return out.index_add_(0, seg, src)
def _pad(x, pw):
    flat = tuple(v for pair in reversed(pw) for v in pair)
    return torch.nn.functional.pad(x, flat)

kernel_name = 'recurrent_scan__sliding_block_cached__geglu_ffn__decode'

def setup_inputs():

    _w = (lambda a: (lambda t: t.to(torch.bfloat16) if t.is_floating_point() else t)(torch.as_tensor(a)))
    def _A_setup():
        B, Sq, D = 1, 1, 512
        Hq, Hkv, Sk, Dh = 32, 8, 65536, 128
        assert Hq % Hkv == 0, (Hq, Hkv)
        return {
            "x": _w((lambda *s: torch.randn(*s, dtype=torch.bfloat16) * 0.05)(B, Sq, D)),
            "k_cache": _w((lambda *s: torch.randn(*s, dtype=torch.bfloat16) * 1.6)(B, Hkv, Sk, Dh)),
            "v_cache": _w((lambda *s: torch.randn(*s, dtype=torch.bfloat16) * 0.2)(B, Hkv, Sk, Dh)),
            "wq": _w((lambda *s: torch.randn(*s, dtype=torch.bfloat16) * 1.6)(D, Hq * Dh) * (D ** -0.5)),
            "wo": _w((lambda *s: torch.randn(*s, dtype=torch.bfloat16) * 0.2)(Hq * Dh, D) * ((Hq * Dh) ** -0.5)),
        }
    _A_in = _A_setup()

    def _B_setup():
        B, S, D, F = 1, 1, 512, 1792
        return {
            "x": _w((lambda *s: torch.randn(*s, dtype=torch.bfloat16) * 0.05)(B, S, D)),
            "w_gate": _w((lambda *s: torch.randn(*s, dtype=torch.bfloat16) * 0.1)(D, F)),
            "w_up": _w((lambda *s: torch.randn(*s, dtype=torch.bfloat16) * 0.1)(D, F)),
            "w_down": _w((lambda *s: torch.randn(*s, dtype=torch.bfloat16) * 0.1)(F, D)),
        }
    _B_in = _B_setup()

    return {
        "A_x": _A_in["x"],
        "A_k_cache": _A_in["k_cache"],
        "A_v_cache": _A_in["v_cache"],
        "A_wq": _A_in["wq"],
        "A_wo": _A_in["wo"],
        "B_x": _B_in["x"],
        "B_w_gate": _B_in["w_gate"],
        "B_w_up": _B_in["w_up"],
        "B_w_down": _B_in["w_down"],
    }

def reference(A_x, A_k_cache, A_v_cache, A_wq, A_wo, B_x, B_w_gate, B_w_up, B_w_down):
    def _A_ref(x, k_cache, v_cache, wq, wo):
        B, Sq, D = x.shape
        Hq, Dh = 32, 128
        Hkv, Sk = k_cache.shape[1], k_cache.shape[2]
        W = min(4096, max(256, Sk // 4))
        rep = Hq // Hkv
        q = (lambda x, *d: x.permute(*d))((x @ wq).reshape(B, Sq, Hq, Dh), 0, 2, 1, 3)
        k = (lambda x, n, axis: torch.repeat_interleave(x, n, dim=axis))(k_cache[:, :, Sk - W:, :], rep, axis=1)
        v = (lambda x, n, axis: torch.repeat_interleave(x, n, dim=axis))(v_cache[:, :, Sk - W:, :], rep, axis=1)
        scores = torch.einsum("bhqd,bhkd->bhqk", q, k) * (Dh ** -0.5)
        p = _softmax(scores, axis=-1)
        o = torch.einsum("bhqk,bhkd->bhqd", p, v)
        return (lambda x, *d: x.permute(*d))(o, 0, 2, 1, 3).reshape(B, Sq, Hq * Dh) @ wo

    def _B_ref(x, w_gate, w_up, w_down):
        return (_gelu(x @ w_gate) * (x @ w_up)) @ w_down

    x = A_x
    xn = _layernorm(x, axis=-1)
    s = _A_ref(xn, A_k_cache, A_v_cache, A_wq, A_wo)
    g = _silu(_B_ref(xn, B_w_gate, B_w_up, B_w_down))
    return x + s * g
```

```asm
; @launch grid=(256,1,1) block=(384,1,1) lds=139264
.amdgcn_target "amdgcn-amd-amdhsa--gfx950"
.text
.globl recurrent_scan__sliding_block_cached__geglu_ffn__decode_kernel
.p2align 12
.fill 832,4,0xBF800000
.p2align 8
.type recurrent_scan__sliding_block_cached__geglu_ffn__decode_kernel,@function
recurrent_scan__sliding_block_cached__geglu_ffn__decode_kernel:
    s_cmp_ge_u32 s2, 256
    s_cbranch_scc1 L_end
    s_load_dwordx16 s[4:19], s[0:1], 0
    s_load_dwordx8 s[20:27], s[0:1], 64
    v_lshrrev_b32 v1, 6, v0
    v_and_b32 v0, 63, v0
    v_readfirstlane_b32 s28, v1
    s_and_b32 s29, s2, 7
    s_lshr_b32 s30, s2, 3
    s_mov_b32 s62, 0
    s_mov_b32 s63, 0x40000
    v_lshrrev_b32 v3, 4, v0
    s_cmp_lg_u32 s28, 1
    s_cbranch_scc1 L_notL
    s_setprio 3
    v_lshrrev_b32 v2, 3, v0
    v_and_b32 v4, 7, v0
    v_lshlrev_b32 v5, 1, v3
    v_xor_b32 v4, v4, v5
    v_lshlrev_b32 v4, 4, v4
    s_lshr_b32 s32, s30, 3
    s_and_b32 s33, s30, 7
    s_lshl_b32 s32, s32, 20
    s_lshl_b32 s33, s33, 7
    s_lshl_b32 s34, s29, 10
    s_add_u32 s32, s32, s33
    s_add_u32 s32, s32, s34
    v_lshl_add_u32 v6, v2, 13, v4
    v_add_u32 v6, s32, v6
    s_mov_b32 s35, 0x10000
    s_movk_i32 s36, 0x400
    s_mov_b32 m0, 0
    s_waitcnt lgkmcnt(0)
L_wq:
    global_load_lds_dwordx4 v6, s[10:11] nt
    s_add_u32 m0, m0, s36
    v_add_u32 v6, s35, v6
    s_cmp_lt_u32 m0, 0x4000
    s_cbranch_scc1 L_wq
    s_branch L_L
L_notL:
    s_cmp_lg_u32 s28, 0
    s_cbranch_scc0 L_Q
    s_cmp_lg_u32 s28, 2
    s_cbranch_scc1 L_A
    s_getpc_b64 s[40:41]
L_pc:
    s_sub_u32 s40, s40, L_pc-recurrent_scan__sliding_block_cached__geglu_ffn__decode_kernel
    s_subb_u32 s41, s41, 0
    v_lshlrev_b32 v4, 7, v0
    v_add_u32 v4, 0x400, v4
    global_load_dword v112, v4, s[40:41]
    v_add_u32 v4, 0x2000, v4
    v_min_u32 v4, L_end-recurrent_scan__sliding_block_cached__geglu_ffn__decode_kernel, v4
    global_load_dword v114, v4, s[40:41]
    s_branch L_A
L_Q:
    v_lshlrev_b32 v2, 4, v0
    v_mov_b32 v50, 0
    s_waitcnt lgkmcnt(0)
    global_load_dwordx4 v[8:11], v2, s[4:5]
    s_load_dword s31, s[26:27], 0
    s_and_b32 s33, s30, 7
    s_lshr_b32 s34, s33, 1
    s_lshl_b32 s34, s34, 11
    s_and_b32 s33, s33, 1
    s_lshl_b32 s33, s33, 8
    s_add_u32 s34, s34, s33
    s_lshr_b32 s33, s30, 3
    s_lshl_b32 s33, s33, 9
    s_add_u32 s34, s34, s33
    s_lshl_b32 s33, s29, 13
    s_add_u32 s34, s34, s33
    s_add_u32 s34, s34, 262144
    v_lshl_add_u32 v48, v0, 2, s34
    v_add_u32 v49, 131072, v48
    global_store_dword v49, v50, s[26:27]
    v_bfe_u32 v4, v0, 2, 2
    v_lshl_add_u32 v4, v3, 2, v4
    v_bfe_u32 v6, v4, 1, 2
    v_and_b32 v7, 3, v0
    v_lshlrev_b32 v7, 3, v7
    v_lshl_add_u32 v7, v4, 7, v7
    v_lshl_add_u32 v40, v6, 5, v7
    v_xor_b32 v41, 32, v40
    v_xor_b32 v42, 64, v40
    v_xor_b32 v43, 0x60, v40
    v_lshlrev_b32 v44, 2, v0
    v_add_u32 v44, 122880, v44
    v_add_u32 v45, 123904, v2
    s_lshr_b32 s32, s30, 3
    s_lshl_b32 s32, s32, 8
    s_add_u32 s32, s32, 123904
    v_lshl_add_u32 v46, v3, 3, s32
    s_barrier
    s_waitcnt vmcnt(1)
    v_lshlrev_b32 v12, 16, v8
    v_and_b32 v13, 0xffff0000, v8
    v_lshlrev_b32 v14, 16, v9
    v_and_b32 v15, 0xffff0000, v9
    v_lshlrev_b32 v16, 16, v10
    v_and_b32 v17, 0xffff0000, v10
    v_lshlrev_b32 v18, 16, v11
    v_and_b32 v19, 0xffff0000, v11
    v_add_f32 v20, v12, v13
    v_add_f32 v21, v14, v15
    v_add_f32 v22, v16, v17
    v_add_f32 v23, v18, v19
    v_add_f32 v20, v20, v21
    v_add_f32 v22, v22, v23
    v_add_f32 v20, v20, v22
    s_nop 1
    v_add_f32_dpp v20, v20, v20 row_ror:8 row_mask:0xf bank_mask:0xf
    s_nop 1
    v_add_f32_dpp v20, v20, v20 row_ror:4 row_mask:0xf bank_mask:0xf
    s_nop 1
    v_add_f32_dpp v20, v20, v20 row_ror:2 row_mask:0xf bank_mask:0xf
    s_nop 1
    v_add_f32_dpp v20, v20, v20 row_ror:1 row_mask:0xf bank_mask:0xf
    v_mov_b32 v21, v20
    s_nop 1
    v_permlane16_swap_b32 v21, v20
    v_add_f32 v20, v21, v20
    v_mov_b32 v21, v20
    s_nop 1
    v_permlane32_swap_b32 v21, v20
    v_add_f32 v20, v21, v20
    v_mul_f32 v20, 0x3b000000, v20
    v_sub_f32 v22, v12, v20
    v_mul_f32 v21, v22, v22
    v_sub_f32 v22, v13, v20
    v_fmac_f32 v21, v22, v22
    v_sub_f32 v22, v14, v20
    v_fmac_f32 v21, v22, v22
    v_sub_f32 v22, v15, v20
    v_fmac_f32 v21, v22, v22
    v_sub_f32 v22, v16, v20
    v_fmac_f32 v21, v22, v22
    v_sub_f32 v22, v17, v20
    v_fmac_f32 v21, v22, v22
    v_sub_f32 v22, v18, v20
    v_fmac_f32 v21, v22, v22
    v_sub_f32 v22, v19, v20
    v_fmac_f32 v21, v22, v22
    s_nop 1
    v_add_f32_dpp v21, v21, v21 row_ror:8 row_mask:0xf bank_mask:0xf
    s_nop 1
    v_add_f32_dpp v21, v21, v21 row_ror:4 row_mask:0xf bank_mask:0xf
    s_nop 1
    v_add_f32_dpp v21, v21, v21 row_ror:2 row_mask:0xf bank_mask:0xf
    s_nop 1
    v_add_f32_dpp v21, v21, v21 row_ror:1 row_mask:0xf bank_mask:0xf
    v_mov_b32 v22, v21
    s_nop 1
    v_permlane16_swap_b32 v22, v21
    v_add_f32 v21, v22, v21
    v_mov_b32 v22, v21
    s_nop 1
    v_permlane32_swap_b32 v22, v21
    v_add_f32 v21, v22, v21
    v_mul_f32 v21, 0x3b000000, v21
    v_cvt_pk_bf16_f32 v20, v20, v20
    v_and_b32 v20, 0xffff0000, v20
    v_cvt_pk_bf16_f32 v21, v21, v21
    v_and_b32 v21, 0xffff0000, v21
    v_add_f32 v21, 0x3727c5ac, v21
    v_cvt_pk_bf16_f32 v21, v21, v21
    v_and_b32 v21, 0xffff0000, v21
    v_sqrt_f32 v21, v21
    s_nop 0
    v_cvt_pk_bf16_f32 v21, v21, v21
    v_and_b32 v21, 0xffff0000, v21
    v_rcp_f32 v21, v21
    v_sub_f32 v12, v12, v20
    v_sub_f32 v13, v13, v20
    v_sub_f32 v14, v14, v20
    v_sub_f32 v15, v15, v20
    v_sub_f32 v16, v16, v20
    v_sub_f32 v17, v17, v20
    v_sub_f32 v18, v18, v20
    v_sub_f32 v19, v19, v20
    v_cvt_pk_bf16_f32 v8, v12, v13
    v_cvt_pk_bf16_f32 v9, v14, v15
    v_cvt_pk_bf16_f32 v10, v16, v17
    v_cvt_pk_bf16_f32 v11, v18, v19
    v_lshlrev_b32 v12, 16, v8
    v_and_b32 v13, 0xffff0000, v8
    v_lshlrev_b32 v14, 16, v9
    v_and_b32 v15, 0xffff0000, v9
    v_lshlrev_b32 v16, 16, v10
    v_and_b32 v17, 0xffff0000, v10
    v_lshlrev_b32 v18, 16, v11
    v_and_b32 v19, 0xffff0000, v11
    v_mul_f32 v12, v12, v21
    v_mul_f32 v13, v13, v21
    v_mul_f32 v14, v14, v21
    v_mul_f32 v15, v15, v21
    v_mul_f32 v16, v16, v21
    v_mul_f32 v17, v17, v21
    v_mul_f32 v18, v18, v21
    v_mul_f32 v19, v19, v21
    v_cvt_pk_bf16_f32 v8, v12, v13
    v_cvt_pk_bf16_f32 v9, v14, v15
    v_cvt_pk_bf16_f32 v10, v16, v17
    v_cvt_pk_bf16_f32 v11, v18, v19
    ds_write_b128 v45, v[8:11]
    ds_read2_b64 v[52:55], v46 offset0:0 offset1:4
    ds_read2_b64 v[56:59], v46 offset0:8 offset1:12
    ds_read2_b64 v[60:63], v46 offset0:16 offset1:20
    ds_read2_b64 v[64:67], v46 offset0:24 offset1:28
    s_waitcnt lgkmcnt(0)
    s_mul_i32 s56, s31, 0x9E3779B1
    s_add_u32 s56, s56, 0x7F4A7C15
    s_or_b32 s56, s56, 0x01010101
    s_cmp_eq_u32 s56, s31
    s_cselect_b32 s31, 2, 0
    s_xor_b32 s31, s31, s56
    s_and_b32 s56, s31, 0xff
    s_bfe_u32 s57, s31, 0x80008
    s_bfe_u32 s58, s31, 0x80010
    s_lshr_b32 s59, s31, 24
    v_and_b32 v51, 3, v0
    v_lshlrev_b32 v51, 3, v51
    v_lshrrev_b32 v51, v51, s31
    s_movk_i32 s60, 0xff00
    s_cmp_ge_u32 s62, 4
    s_cbranch_scc1 L_wd3
L_wl2:
    ds_read_b32 v5, v44
    s_waitcnt lgkmcnt(0)
    v_readfirstlane_b32 s62, v5
    s_cmp_ge_u32 s62, 4
    s_cbranch_scc1 L_wd3
    s_sub_u32 s63, s63, 1
    s_cbranch_scc1 L_end
    s_branch L_wl2
L_wd3:
    ds_read_b64_tr_b16 v[68:69], v40 offset:0
    ds_read_b64_tr_b16 v[70:71], v40 offset:2048
    ds_read_b64_tr_b16 v[72:73], v41 offset:0
    ds_read_b64_tr_b16 v[74:75], v41 offset:2048
    ds_read_b64_tr_b16 v[76:77], v42 offset:0
    ds_read_b64_tr_b16 v[78:79], v42 offset:2048
    ds_read_b64_tr_b16 v[80:81], v43 offset:0
    ds_read_b64_tr_b16 v[82:83], v43 offset:2048
    s_waitcnt lgkmcnt(6)
    v_mfma_f32_16x16x32_bf16 v[84:87], v[52:55], v[68:71], 0
    s_waitcnt lgkmcnt(4)
    v_mfma_f32_16x16x32_bf16 v[88:91], v[52:55], v[72:75], 0
    s_waitcnt lgkmcnt(2)
    v_mfma_f32_16x16x32_bf16 v[92:95], v[52:55], v[76:79], 0
    s_waitcnt lgkmcnt(0)
    v_mfma_f32_16x16x32_bf16 v[96:99], v[52:55], v[80:83], 0
    s_cmp_ge_u32 s62, 8
    s_cbranch_scc1 L_wd5
L_wl4:
    ds_read_b32 v5, v44
    s_waitcnt lgkmcnt(0)
    v_readfirstlane_b32 s62, v5
    s_cmp_ge_u32 s62, 8
    s_cbranch_scc1 L_wd5
    s_sub_u32 s63, s63, 1
    s_cbranch_scc1 L_end
    s_branch L_wl4
L_wd5:
    ds_read_b64_tr_b16 v[68:69], v40 offset:4096
    ds_read_b64_tr_b16 v[70:71], v40 offset:6144
    ds_read_b64_tr_b16 v[72:73], v41 offset:4096
    ds_read_b64_tr_b16 v[74:75], v41 offset:6144
    ds_read_b64_tr_b16 v[76:77], v42 offset:4096
    ds_read_b64_tr_b16 v[78:79], v42 offset:6144
    ds_read_b64_tr_b16 v[80:81], v43 offset:4096
    ds_read_b64_tr_b16 v[82:83], v43 offset:6144
    s_waitcnt lgkmcnt(6)
    v_mfma_f32_16x16x32_bf16 v[84:87], v[56:59], v[68:71], v[84:87]
    s_waitcnt lgkmcnt(4)
    v_mfma_f32_16x16x32_bf16 v[88:91], v[56:59], v[72:75], v[88:91]
    s_waitcnt lgkmcnt(2)
    v_mfma_f32_16x16x32_bf16 v[92:95], v[56:59], v[76:79], v[92:95]
    s_waitcnt lgkmcnt(0)
    v_mfma_f32_16x16x32_bf16 v[96:99], v[56:59], v[80:83], v[96:99]
    s_cmp_ge_u32 s62, 12
    s_cbranch_scc1 L_wd7
L_wl6:
    ds_read_b32 v5, v44
    s_waitcnt lgkmcnt(0)
    v_readfirstlane_b32 s62, v5
    s_cmp_ge_u32 s62, 12
    s_cbranch_scc1 L_wd7
    s_sub_u32 s63, s63, 1
    s_cbranch_scc1 L_end
    s_branch L_wl6
L_wd7:
    ds_read_b64_tr_b16 v[68:69], v40 offset:8192
    ds_read_b64_tr_b16 v[70:71], v40 offset:10240
    ds_read_b64_tr_b16 v[72:73], v41 offset:8192
    ds_read_b64_tr_b16 v[74:75], v41 offset:10240
    ds_read_b64_tr_b16 v[76:77], v42 offset:8192
    ds_read_b64_tr_b16 v[78:79], v42 offset:10240
    ds_read_b64_tr_b16 v[80:81], v43 offset:8192
    ds_read_b64_tr_b16 v[82:83], v43 offset:10240
    s_waitcnt lgkmcnt(6)
    v_mfma_f32_16x16x32_bf16 v[84:87], v[60:63], v[68:71], v[84:87]
    s_waitcnt lgkmcnt(4)
    v_mfma_f32_16x16x32_bf16 v[88:91], v[60:63], v[72:75], v[88:91]
    s_waitcnt lgkmcnt(2)
    v_mfma_f32_16x16x32_bf16 v[92:95], v[60:63], v[76:79], v[92:95]
    s_waitcnt lgkmcnt(0)
    v_mfma_f32_16x16x32_bf16 v[96:99], v[60:63], v[80:83], v[96:99]
    s_cmp_ge_u32 s62, 16
    s_cbranch_scc1 L_wd9
L_wl8:
    ds_read_b32 v5, v44
    s_waitcnt lgkmcnt(0)
    v_readfirstlane_b32 s62, v5
    s_cmp_ge_u32 s62, 16
    s_cbranch_scc1 L_wd9
    s_sub_u32 s63, s63, 1
    s_cbranch_scc1 L_end
    s_branch L_wl8
L_wd9:
    ds_read_b64_tr_b16 v[68:69], v40 offset:12288
    ds_read_b64_tr_b16 v[70:71], v40 offset:14336
    ds_read_b64_tr_b16 v[72:73], v41 offset:12288
    ds_read_b64_tr_b16 v[74:75], v41 offset:14336
    ds_read_b64_tr_b16 v[76:77], v42 offset:12288
    ds_read_b64_tr_b16 v[78:79], v42 offset:14336
    ds_read_b64_tr_b16 v[80:81], v43 offset:12288
    ds_read_b64_tr_b16 v[82:83], v43 offset:14336
    s_waitcnt lgkmcnt(6)
    v_mfma_f32_16x16x32_bf16 v[84:87], v[64:67], v[68:71], v[84:87]
    s_waitcnt lgkmcnt(4)
    v_mfma_f32_16x16x32_bf16 v[88:91], v[64:67], v[72:75], v[88:91]
    s_waitcnt lgkmcnt(2)
    v_mfma_f32_16x16x32_bf16 v[92:95], v[64:67], v[76:79], v[92:95]
    s_waitcnt lgkmcnt(0)
    v_mfma_f32_16x16x32_bf16 v[96:99], v[64:67], v[80:83], v[96:99]
    s_nop 1
    v_mov_b32 v50, v84
    s_nop 0
    v_mov_b32_dpp v50, v88 quad_perm:[0,1,2,3] row_mask:2 bank_mask:0xf
    s_nop 0
    v_mov_b32_dpp v50, v92 quad_perm:[0,1,2,3] row_mask:4 bank_mask:0xf
    s_nop 0
    v_mov_b32_dpp v50, v96 quad_perm:[0,1,2,3] row_mask:8 bank_mask:0xf
    v_bfi_b32 v50, s60, v50, v51
    global_store_dword v49, v50, s[26:27]
    global_store_dword v48, v50, s[26:27] sc1
    s_cmp_ge_u32 s30, 28
    s_cbranch_scc1 L_Qend
    s_lshl_b32 s47, s29, 2
    s_lshr_b32 s47, 0x44444444, s47
    s_and_b32 s47, s47, 15
    s_bfe_u32 s32, s29, 0x10001
    s_lshl_b32 s32, s32, 8
    s_sub_u32 s33, 8, s47
    s_lshl_b32 s33, s33, 5
    s_cmp_ge_u32 s29, 4
    s_cselect_b32 s33, s33, 0
    s_add_u32 s32, s32, s33
    s_lshl_b32 s32, s32, 1
    s_add_u32 s32, s32, 123904
    v_lshl_add_u32 v47, v3, 3, s32
    ds_read2_b64 v[100:103], v47 offset0:0 offset1:4
    ds_read2_b64 v[104:107], v47 offset0:8 offset1:12
    ds_read2_b64 v[108:111], v47 offset0:16 offset1:20
    ds_read2_b64 v[112:115], v47 offset0:24 offset1:28
    v_add_u32 v40, 16384, v40
    v_add_u32 v41, 16384, v41
    v_add_u32 v42, 16384, v42
    v_add_u32 v43, 16384, v43
    s_lshl_b32 s32, s30, 11
    s_add_u32 s32, s32, 131072
    v_lshl_add_u32 v49, v0, 4, s32
    s_lshl_b32 s33, s29, 8
    s_add_u32 s32, s32, s33
    v_lshl_add_u32 v48, v0, 2, s32
    s_waitcnt lgkmcnt(0)
    s_cmp_ge_u32 s62, 20
    s_cbranch_scc1 L_wd12
L_wl11:
    ds_read_b32 v5, v44
    s_waitcnt lgkmcnt(0)
    v_readfirstlane_b32 s62, v5
    s_cmp_ge_u32 s62, 20
    s_cbranch_scc1 L_wd12
    s_sub_u32 s63, s63, 1
    s_cbranch_scc1 L_end
    s_branch L_wl11
L_wd12:
    ds_read_b64_tr_b16 v[68:69], v40 offset:0
    ds_read_b64_tr_b16 v[70:71], v40 offset:2048
    ds_read_b64_tr_b16 v[72:73], v41 offset:0
    ds_read_b64_tr_b16 v[74:75], v41 offset:2048
    ds_read_b64_tr_b16 v[76:77], v42 offset:0
    ds_read_b64_tr_b16 v[78:79], v42 offset:2048
    ds_read_b64_tr_b16 v[80:81], v43 offset:0
    ds_read_b64_tr_b16 v[82:83], v43 offset:2048
    s_waitcnt lgkmcnt(6)
    v_mfma_f32_16x16x32_bf16 v[84:87], v[100:103], v[68:71], 0
    s_waitcnt lgkmcnt(4)
    v_mfma_f32_16x16x32_bf16 v[88:91], v[100:103], v[72:75], 0
    s_waitcnt lgkmcnt(2)
    v_mfma_f32_16x16x32_bf16 v[92:95], v[100:103], v[76:79], 0
    s_waitcnt lgkmcnt(0)
    v_mfma_f32_16x16x32_bf16 v[96:99], v[100:103], v[80:83], 0
    s_cmp_ge_u32 s62, 24
    s_cbranch_scc1 L_wd14
L_wl13:
    ds_read_b32 v5, v44
    s_waitcnt lgkmcnt(0)
    v_readfirstlane_b32 s62, v5
    s_cmp_ge_u32 s62, 24
    s_cbranch_scc1 L_wd14
    s_sub_u32 s63, s63, 1
    s_cbranch_scc1 L_end
    s_branch L_wl13
L_wd14:
    ds_read_b64_tr_b16 v[68:69], v40 offset:4096
    ds_read_b64_tr_b16 v[70:71], v40 offset:6144
    ds_read_b64_tr_b16 v[72:73], v41 offset:4096
    ds_read_b64_tr_b16 v[74:75], v41 offset:6144
    ds_read_b64_tr_b16 v[76:77], v42 offset:4096
    ds_read_b64_tr_b16 v[78:79], v42 offset:6144
    ds_read_b64_tr_b16 v[80:81], v43 offset:4096
    ds_read_b64_tr_b16 v[82:83], v43 offset:6144
    s_waitcnt lgkmcnt(6)
    v_mfma_f32_16x16x32_bf16 v[84:87], v[104:107], v[68:71], v[84:87]
    s_waitcnt lgkmcnt(4)
    v_mfma_f32_16x16x32_bf16 v[88:91], v[104:107], v[72:75], v[88:91]
    s_waitcnt lgkmcnt(2)
    v_mfma_f32_16x16x32_bf16 v[92:95], v[104:107], v[76:79], v[92:95]
    s_waitcnt lgkmcnt(0)
    v_mfma_f32_16x16x32_bf16 v[96:99], v[104:107], v[80:83], v[96:99]
    s_cmp_ge_u32 s62, 28
    s_cbranch_scc1 L_wd16
L_wl15:
    ds_read_b32 v5, v44
    s_waitcnt lgkmcnt(0)
    v_readfirstlane_b32 s62, v5
    s_cmp_ge_u32 s62, 28
    s_cbranch_scc1 L_wd16
    s_sub_u32 s63, s63, 1
    s_cbranch_scc1 L_end
    s_branch L_wl15
L_wd16:
    ds_read_b64_tr_b16 v[68:69], v40 offset:8192
    ds_read_b64_tr_b16 v[70:71], v40 offset:10240
    ds_read_b64_tr_b16 v[72:73], v41 offset:8192
    ds_read_b64_tr_b16 v[74:75], v41 offset:10240
    ds_read_b64_tr_b16 v[76:77], v42 offset:8192
    ds_read_b64_tr_b16 v[78:79], v42 offset:10240
    ds_read_b64_tr_b16 v[80:81], v43 offset:8192
    ds_read_b64_tr_b16 v[82:83], v43 offset:10240
    s_waitcnt lgkmcnt(6)
    v_mfma_f32_16x16x32_bf16 v[84:87], v[108:111], v[68:71], v[84:87]
    s_waitcnt lgkmcnt(4)
    v_mfma_f32_16x16x32_bf16 v[88:91], v[108:111], v[72:75], v[88:91]
    s_waitcnt lgkmcnt(2)
    v_mfma_f32_16x16x32_bf16 v[92:95], v[108:111], v[76:79], v[92:95]
    s_waitcnt lgkmcnt(0)
    v_mfma_f32_16x16x32_bf16 v[96:99], v[108:111], v[80:83], v[96:99]
    s_cmp_ge_u32 s62, 32
    s_cbranch_scc1 L_wd18
L_wl17:
    ds_read_b32 v5, v44
    s_waitcnt lgkmcnt(0)
    v_readfirstlane_b32 s62, v5
    s_cmp_ge_u32 s62, 32
    s_cbranch_scc1 L_wd18
    s_sub_u32 s63, s63, 1
    s_cbranch_scc1 L_end
    s_branch L_wl17
L_wd18:
    ds_read_b64_tr_b16 v[68:69], v40 offset:12288
    ds_read_b64_tr_b16 v[70:71], v40 offset:14336
    ds_read_b64_tr_b16 v[72:73], v41 offset:12288
    ds_read_b64_tr_b16 v[74:75], v41 offset:14336
    ds_read_b64_tr_b16 v[76:77], v42 offset:12288
    ds_read_b64_tr_b16 v[78:79], v42 offset:14336
    ds_read_b64_tr_b16 v[80:81], v43 offset:12288
    ds_read_b64_tr_b16 v[82:83], v43 offset:14336
    s_waitcnt lgkmcnt(6)
    v_mfma_f32_16x16x32_bf16 v[84:87], v[112:115], v[68:71], v[84:87]
    s_waitcnt lgkmcnt(4)
    v_mfma_f32_16x16x32_bf16 v[88:91], v[112:115], v[72:75], v[88:91]
    s_waitcnt lgkmcnt(2)
    v_mfma_f32_16x16x32_bf16 v[92:95], v[112:115], v[76:79], v[92:95]
    s_waitcnt lgkmcnt(0)
    v_mfma_f32_16x16x32_bf16 v[96:99], v[112:115], v[80:83], v[96:99]
    s_nop 1
    v_mov_b32 v50, v84
    s_nop 0
    v_mov_b32_dpp v50, v88 quad_perm:[0,1,2,3] row_mask:2 bank_mask:0xf
    s_nop 0
    v_mov_b32_dpp v50, v92 quad_perm:[0,1,2,3] row_mask:4 bank_mask:0xf
    s_nop 0
    v_mov_b32_dpp v50, v96 quad_perm:[0,1,2,3] row_mask:8 bank_mask:0xf
    v_bfi_b32 v50, s60, v50, v51
    global_store_dword v48, v50, s[26:27] sc1
    s_lshl_b32 s32, s29, 14
    s_add_u32 s32, s32, 1048576
    s_cmp_ge_u32 s30, 16
    s_cbranch_scc1 L_fp19
    s_lshl_b32 s33, s30, 10
    s_add_u32 s33, s33, s32
    v_lshl_add_u32 v4, v0, 4, s33
    global_load_dword v36, v4, s[26:27] sc1
L_fp19:
    s_lshl_b32 s33, s30, 4
    s_add_u32 s32, s32, s33
    s_add_u32 s32, s32, 0x200
    v_lshrrev_b32 v4, 2, v0
    v_and_b32 v6, 3, v0
    v_lshlrev_b32 v6, 2, v6
    v_lshl_add_u32 v6, v4, 10, v6
    v_add_u32 v6, s32, v6
    v_and_b32 v7, 15, v0
    v_lshlrev_b32 v7, 3, v7
    v_lshrrev_b32 v4, 5, v0
    v_lshl_add_u32 v7, v4, 2, v7
    v_add_u32 v7, 123392, v7
    v_lshlrev_b32 v4, 3, v3
    v_add_u32 v4, 123392, v4
    v_add_u32 v40, 98304, v40
    v_add_u32 v41, 98304, v41
    v_add_u32 v42, 98304, v42
    v_add_u32 v43, 98304, v43
    s_lshl_b32 s32, s29, 8
    s_add_u32 s32, s32, 4096
    v_and_b32 v46, 31, v0
    v_lshl_add_u32 v47, v46, 3, s32
    s_mov_b32 s34, 68
    s_cmp_ge_u32 s62, s34
    s_cbranch_scc1 L_wd21
L_wl20:
    ds_read_b32 v5, v44
    s_waitcnt lgkmcnt(0)
    v_readfirstlane_b32 s62, v5
    s_cmp_ge_u32 s62, s34
    s_cbranch_scc1 L_wd21
    s_sleep 1
    s_sub_u32 s63, s63, 1
    s_cbranch_scc1 L_end
    s_branch L_wl20
L_wd21:
L_hf22:
    global_load_dwordx4 v[8:11], v49, s[26:27] offset:0 sc1
    global_load_dwordx4 v[12:15], v49, s[26:27] offset:1024 sc1
    global_load_dwordx2 v[24:25], v47, s[26:27] sc1
    s_sub_u32 s63, s63, 1
    s_cbranch_scc1 L_end
    s_waitcnt vmcnt(0)
    v_xor_b32 v8, s56, v8
    v_xor_b32 v9, s57, v9
    v_xor_b32 v10, s58, v10
    v_xor_b32 v11, s59, v11
    v_xor_b32 v12, s56, v12
    v_xor_b32 v13, s57, v13
    v_xor_b32 v14, s58, v14
    v_xor_b32 v15, s59, v15
    v_or3_b32 v5, v8, v9, v10
    v_or3_b32 v5, v5, v11, v12
    v_or3_b32 v5, v5, v13, v14
    v_or_b32 v5, v5, v15
    v_and_b32 v5, 0xff, v5
    v_bitop3_b32 v5, v25, s31, v5 bitop3:0xbe
    v_cmp_ne_u32 vcc, 0, v5
    s_mov_b64 exec, vcc
    s_cbranch_execnz L_hf22
    s_mov_b64 exec, -1
    s_getreg_b32 s32, hwreg(HW_REG_XCC_ID)
    v_cmp_ne_u32 vcc, s32, v24
    s_cmp_eq_u64 vcc, 0
    s_cselect_b32 s61, 1, 0
    v_add_f32 v8, v8, v12
    v_add_f32 v9, v9, v13
    v_add_f32 v10, v10, v14
    v_add_f32 v11, v11, v15
    s_nop 0
    v_permlane32_swap_b32 v8, v10
    v_permlane32_swap_b32 v9, v11
    v_add_f32 v8, v8, v10
    v_add_f32 v9, v9, v11
    v_cvt_pk_bf16_f32 v8, v8, v9
    v_mov_b32 v9, v8
    s_nop 1
    v_permlane16_swap_b32 v8, v9
    v_lshlrev_b32 v10, 16, v8
    v_and_b32 v11, 0xffff0000, v8
    v_lshlrev_b32 v12, 16, v9
    v_and_b32 v13, 0xffff0000, v9
    s_mov_b32 s32, 0xbdd2d3e8
    v_mov_b32 v18, 0xc0135761
    v_mul_f32 v14, v10, v10
    v_mul_f32 v15, v11, v11
    v_fma_f32 v14, v14, s32, v18
    v_fma_f32 v15, v15, s32, v18
    v_mul_f32 v14, v14, v10
    v_mul_f32 v15, v15, v11
    v_exp_f32 v14, v14
    v_exp_f32 v15, v15
    v_add_f32 v14, 1.0, v14
    v_add_f32 v15, 1.0, v15
    v_rcp_f32 v14, v14
    v_rcp_f32 v15, v15
    v_mul_f32 v10, v10, v14
    v_mul_f32 v11, v11, v15
    v_cvt_pk_bf16_f32 v8, v10, v11
    v_lshlrev_b32 v10, 16, v8
    v_and_b32 v11, 0xffff0000, v8
    v_mul_f32 v10, v10, v12
    v_mul_f32 v11, v11, v13
    v_cvt_pk_bf16_f32 v8, v10, v11
    ds_write_b32 v7, v8
    ds_read2_b64 v[52:55], v4 offset0:0 offset1:4
    ds_read2_b64 v[56:59], v4 offset0:8 offset1:12
    s_cmp_ge_u32 s62, 112
    s_cbranch_scc1 L_wd24
L_wl23:
    ds_read_b32 v5, v44
    s_waitcnt lgkmcnt(0)
    v_readfirstlane_b32 s62, v5
    s_cmp_ge_u32 s62, 112
    s_cbranch_scc1 L_wd24
    s_sleep 1
    s_sub_u32 s63, s63, 1
    s_cbranch_scc1 L_end
    s_branch L_wl23
L_wd24:
    s_waitcnt lgkmcnt(0)
    s_cmp_ge_u32 s62, 116
    s_cbranch_scc1 L_wd27
L_wl26:
    ds_read_b32 v5, v44
    s_waitcnt lgkmcnt(0)
    v_readfirstlane_b32 s62, v5
    s_cmp_ge_u32 s62, 116
    s_cbranch_scc1 L_wd27
    s_sub_u32 s63, s63, 1
    s_cbranch_scc1 L_end
    s_branch L_wl26
L_wd27:
    ds_read_b64_tr_b16 v[68:69], v40 offset:0
    ds_read_b64_tr_b16 v[70:71], v40 offset:2048
    ds_read_b64_tr_b16 v[72:73], v41 offset:0
    ds_read_b64_tr_b16 v[74:75], v41 offset:2048
    ds_read_b64_tr_b16 v[76:77], v42 offset:0
    ds_read_b64_tr_b16 v[78:79], v42 offset:2048
    ds_read_b64_tr_b16 v[80:81], v43 offset:0
    ds_read_b64_tr_b16 v[82:83], v43 offset:2048
    s_waitcnt lgkmcnt(6)
    v_mfma_f32_16x16x32_bf16 v[84:87], v[52:55], v[68:71], 0
    s_waitcnt lgkmcnt(4)
    v_mfma_f32_16x16x32_bf16 v[88:91], v[52:55], v[72:75], 0
    s_waitcnt lgkmcnt(2)
    v_mfma_f32_16x16x32_bf16 v[92:95], v[52:55], v[76:79], 0
    s_waitcnt lgkmcnt(0)
    v_mfma_f32_16x16x32_bf16 v[96:99], v[52:55], v[80:83], 0
    s_cmp_ge_u32 s62, 120
    s_cbranch_scc1 L_wd29
L_wl28:
    ds_read_b32 v5, v44
    s_waitcnt lgkmcnt(0)
    v_readfirstlane_b32 s62, v5
    s_cmp_ge_u32 s62, 120
    s_cbranch_scc1 L_wd29
    s_sub_u32 s63, s63, 1
    s_cbranch_scc1 L_end
    s_branch L_wl28
L_wd29:
    ds_read_b64_tr_b16 v[68:69], v40 offset:4096
    ds_read_b64_tr_b16 v[70:71], v40 offset:6144
    ds_read_b64_tr_b16 v[72:73], v41 offset:4096
    ds_read_b64_tr_b16 v[74:75], v41 offset:6144
    ds_read_b64_tr_b16 v[76:77], v42 offset:4096
    ds_read_b64_tr_b16 v[78:79], v42 offset:6144
    ds_read_b64_tr_b16 v[80:81], v43 offset:4096
    ds_read_b64_tr_b16 v[82:83], v43 offset:6144
    s_waitcnt lgkmcnt(6)
    v_mfma_f32_16x16x32_bf16 v[84:87], v[56:59], v[68:71], v[84:87]
    s_waitcnt lgkmcnt(4)
    v_mfma_f32_16x16x32_bf16 v[88:91], v[56:59], v[72:75], v[88:91]
    s_waitcnt lgkmcnt(2)
    v_mfma_f32_16x16x32_bf16 v[92:95], v[56:59], v[76:79], v[92:95]
    s_waitcnt lgkmcnt(0)
    v_mfma_f32_16x16x32_bf16 v[96:99], v[56:59], v[80:83], v[96:99]
    s_nop 1
    v_mov_b32 v50, v84
    s_nop 0
    v_mov_b32_dpp v50, v88 quad_perm:[0,1,2,3] row_mask:2 bank_mask:0xf
    s_nop 0
    v_mov_b32_dpp v50, v92 quad_perm:[0,1,2,3] row_mask:4 bank_mask:0xf
    s_nop 0
    v_mov_b32_dpp v50, v96 quad_perm:[0,1,2,3] row_mask:8 bank_mask:0xf
    v_bfi_b32 v50, s60, v50, v51
    s_cmp_eq_u32 s61, 1
    s_cbranch_scc0 L_p330
    global_store_dword v6, v50, s[26:27]
    s_branch L_p3e31
L_p330:
    global_store_dword v6, v50, s[26:27] sc1
L_p3e31:
L_Qend:
    s_endpgm
L_L:
    s_bitcmp1_b32 s29, 0
    s_cselect_b32 s16, s18, s16
    s_cselect_b32 s17, s19, s17
    s_lshl_b32 s47, s29, 2
    s_lshr_b32 s47, 0x44444444, s47
    s_and_b32 s47, s47, 15
    s_bfe_u32 s32, s29, 0x10001
    s_lshl_b32 s32, s32, 8
    s_sub_u32 s33, 8, s47
    s_lshl_b32 s33, s33, 5
    s_cmp_ge_u32 s29, 4
    s_cselect_b32 s33, s33, 0
    s_add_u32 s32, s32, s33
    s_mul_i32 s32, s32, 3584
    s_lshl_b32 s33, s30, 7
    s_add_u32 s32, s32, s33
    s_movk_i32 s33, 3584
    v_mad_u32_u24 v14, v2, s33, v4
    v_add_u32 v14, s32, v14
    s_cmp_lt_u32 s30, 28
    s_cselect_b32 s34, -1, 0
    s_cselect_b32 s38, 28672, 0
    s_cselect_b32 s39, 0x2000, 0
    v_and_b32 v14, s34, v14
    s_barrier
    s_load_dword s31, s[26:27], 0
    s_lshl_b32 s32, s30, 16
    s_lshl_b32 s33, s29, 7
    s_add_u32 s32, s32, s33
    v_lshl_add_u32 v16, v2, 10, v4
    v_add_u32 v16, s32, v16
    v_and_b32 v16, s34, v16
    v_lshlrev_b32 v21, 2, v0
    v_add_u32 v21, 122880, v21
    v_lshrrev_b32 v17, 5, v0
    v_lshlrev_b32 v17, 2, v17
    v_bfe_u32 v18, v0, 4, 1
    v_add_u32 v17, v17, v18
    v_bfe_u32 v18, v0, 3, 1
    v_lshl_add_u32 v17, v18, 4, v17
    s_lshl_b32 s32, s30, 17
    s_add_u32 s32, s32, s33
    v_lshl_add_u32 v15, v17, 10, v4
    v_add_u32 v15, s32, v15
    s_movk_i32 s44, 8192
    s_movk_i32 s45, -6144
    s_movk_i32 s46, 22528
    s_lshl_b32 s33, s30, 10
    s_lshl_b32 s32, s29, 24
    s_add_u32 s32, s32, s33
    s_add_u32 s32, s32, 0xF00000
    v_and_b32 v7, 15, v0
    v_xor_b32 v8, v7, v3
    v_lshlrev_b32 v8, 4, v8
    v_lshl_add_u32 v8, v3, 8, v8
    v_add_u32 v8, s32, v8
    v_xor_b32 v12, v7, v5
    v_lshlrev_b32 v12, 4, v12
    v_lshl_add_u32 v12, v3, 8, v12
    v_add_u32 v12, s32, v12
    v_xor_b32 v9, 33856, v8
    v_xor_b32 v13, 33920, v12
    v_xor_b32 v10, 67712, v8
    v_xor_b32 v18, 67584, v12
    v_xor_b32 v11, 101568, v8
    v_xor_b32 v19, 101504, v12
    global_load_lds_dwordx4 v14, s[16:17] nt
    s_add_u32 m0, m0, s36
    v_add_u32 v14, s38, v14
    global_load_lds_dwordx4 v14, s[16:17] nt
    s_add_u32 m0, m0, s36
    v_add_u32 v14, s38, v14
    global_load_lds_dwordx4 v14, s[16:17] nt
    s_add_u32 m0, m0, s36
    v_add_u32 v14, s38, v14
    global_load_lds_dwordx4 v14, s[16:17] nt
    s_add_u32 m0, m0, s36
    v_add_u32 v14, s38, v14
    global_load_lds_dwordx4 v14, s[16:17] nt
    s_add_u32 m0, m0, s36
    v_add_u32 v14, s38, v14
    global_load_lds_dwordx4 v14, s[16:17] nt
    s_add_u32 m0, m0, s36
    v_add_u32 v14, s38, v14
    global_load_lds_dwordx4 v14, s[16:17] nt
    s_add_u32 m0, m0, s36
    v_add_u32 v14, s38, v14
    global_load_lds_dwordx4 v14, s[16:17] nt
    s_add_u32 m0, m0, s36
    v_add_u32 v14, s38, v14
    v_mov_b32 v20, 4
    s_waitcnt vmcnt(20) lgkmcnt(0)
    ds_write_b32 v21, v20
    global_load_lds_dwordx4 v14, s[16:17] nt
    s_add_u32 m0, m0, s36
    v_add_u32 v14, s38, v14
    global_load_lds_dwordx4 v14, s[16:17] nt
    s_add_u32 m0, m0, s36
    v_add_u32 v14, s38, v14
    global_load_lds_dwordx4 v14, s[16:17] nt
    s_add_u32 m0, m0, s36
    v_add_u32 v14, s38, v14
    global_load_lds_dwordx4 v14, s[16:17] nt
    s_add_u32 m0, m0, s36
    v_add_u32 v14, s38, v14
    v_mov_b32 v20, 8
    s_waitcnt vmcnt(20)
    ds_write_b32 v21, v20
    global_load_lds_dwordx4 v14, s[16:17] nt
    s_add_u32 m0, m0, s36
    v_add_u32 v14, s38, v14
    global_load_lds_dwordx4 v14, s[16:17] nt
    s_add_u32 m0, m0, s36
    v_add_u32 v14, s38, v14
    global_load_lds_dwordx4 v14, s[16:17] nt
    s_add_u32 m0, m0, s36
    v_add_u32 v14, s38, v14
    global_load_lds_dwordx4 v14, s[16:17] nt
    s_add_u32 m0, m0, s36
    v_add_u32 v14, s38, v14
    v_mov_b32 v20, 12
    s_waitcnt vmcnt(20)
    ds_write_b32 v21, v20
    global_load_lds_dwordx4 v8, s[6:7] nt
    s_add_u32 m0, m0, s36
    v_xor_b32 v8, 4096, v8
    global_load_lds_dwordx4 v9, s[6:7] nt
    s_add_u32 m0, m0, s36
    v_xor_b32 v9, 4096, v9
    global_load_lds_dwordx4 v10, s[6:7] nt
    s_add_u32 m0, m0, s36
    v_xor_b32 v10, 4096, v10
    global_load_lds_dwordx4 v11, s[6:7] nt
    s_add_u32 m0, m0, s36
    v_xor_b32 v11, 4096, v11
    s_add_u32 s6, s6, 0x20000
    s_addc_u32 s7, s7, 0
    v_mov_b32 v20, 16
    s_waitcnt vmcnt(20)
    ds_write_b32 v21, v20
    global_load_lds_dwordx4 v8, s[6:7] nt
    s_add_u32 m0, m0, s36
    v_xor_b32 v8, 12288, v8
    global_load_lds_dwordx4 v9, s[6:7] nt
    s_add_u32 m0, m0, s36
    v_xor_b32 v9, 12288, v9
    global_load_lds_dwordx4 v10, s[6:7] nt
    s_add_u32 m0, m0, s36
    v_xor_b32 v10, 12288, v10
    global_load_lds_dwordx4 v11, s[6:7] nt
    s_add_u32 m0, m0, s36
    v_xor_b32 v11, 12288, v11
    s_add_u32 s6, s6, 0x20000
    s_addc_u32 s7, s7, 0
    v_mov_b32 v20, 20
    s_waitcnt vmcnt(20)
    ds_write_b32 v21, v20
    global_load_lds_dwordx4 v8, s[6:7] nt
    s_add_u32 m0, m0, s36
    v_xor_b32 v8, 4096, v8
    global_load_lds_dwordx4 v9, s[6:7] nt
    s_add_u32 m0, m0, s36
    v_xor_b32 v9, 4096, v9
    global_load_lds_dwordx4 v10, s[6:7] nt
    s_add_u32 m0, m0, s36
    v_xor_b32 v10, 4096, v10
    global_load_lds_dwordx4 v11, s[6:7] nt
    s_add_u32 m0, m0, s36
    v_xor_b32 v11, 4096, v11
    s_add_u32 s6, s6, 0x20000
    s_addc_u32 s7, s7, 0
    v_mov_b32 v20, 24
    s_waitcnt vmcnt(20)
    ds_write_b32 v21, v20
    global_load_lds_dwordx4 v8, s[6:7] nt
    s_add_u32 m0, m0, s36
    v_xor_b32 v8, 28672, v8
    global_load_lds_dwordx4 v9, s[6:7] nt
    s_add_u32 m0, m0, s36
    v_xor_b32 v9, 28672, v9
    global_load_lds_dwordx4 v10, s[6:7] nt
    s_add_u32 m0, m0, s36
    v_xor_b32 v10, 28672, v10
    global_load_lds_dwordx4 v11, s[6:7] nt
    s_add_u32 m0, m0, s36
    v_xor_b32 v11, 28672, v11
    s_add_u32 s6, s6, 0x20000
    s_addc_u32 s7, s7, 0
    v_mov_b32 v20, 28
    s_waitcnt vmcnt(20)
    ds_write_b32 v21, v20
    global_load_lds_dwordx4 v8, s[6:7] nt
    s_add_u32 m0, m0, s36
    v_xor_b32 v8, 4096, v8
    global_load_lds_dwordx4 v9, s[6:7] nt
    s_add_u32 m0, m0, s36
    v_xor_b32 v9, 4096, v9
    global_load_lds_dwordx4 v10, s[6:7] nt
    s_add_u32 m0, m0, s36
    v_xor_b32 v10, 4096, v10
    global_load_lds_dwordx4 v11, s[6:7] nt
    s_add_u32 m0, m0, s36
    v_xor_b32 v11, 4096, v11
    s_add_u32 s6, s6, 0x20000
    s_addc_u32 s7, s7, 0
    v_mov_b32 v20, 32
    s_waitcnt vmcnt(20)
    ds_write_b32 v21, v20
    global_load_lds_dwordx4 v8, s[6:7] nt
    s_add_u32 m0, m0, s36
    v_xor_b32 v8, 12288, v8
    global_load_lds_dwordx4 v9, s[6:7] nt
    s_add_u32 m0, m0, s36
    v_xor_b32 v9, 12288, v9
    global_load_lds_dwordx4 v10, s[6:7] nt
    s_add_u32 m0, m0, s36
    v_xor_b32 v10, 12288, v10
    global_load_lds_dwordx4 v11, s[6:7] nt
    s_add_u32 m0, m0, s36
    v_xor_b32 v11, 12288, v11
    s_add_u32 s6, s6, 0x20000
    s_addc_u32 s7, s7, 0
    v_mov_b32 v20, 36
    s_waitcnt vmcnt(20)
    ds_write_b32 v21, v20
    global_load_lds_dwordx4 v8, s[6:7] nt
    s_add_u32 m0, m0, s36
    v_xor_b32 v8, 4096, v8
    global_load_lds_dwordx4 v9, s[6:7] nt
    s_add_u32 m0, m0, s36
    v_xor_b32 v9, 4096, v9
    global_load_lds_dwordx4 v10, s[6:7] nt
    s_add_u32 m0, m0, s36
    v_xor_b32 v10, 4096, v10
    global_load_lds_dwordx4 v11, s[6:7] nt
    s_add_u32 m0, m0, s36
    v_xor_b32 v11, 4096, v11
    s_add_u32 s6, s6, 0x20000
    s_addc_u32 s7, s7, 0
    v_mov_b32 v20, 40
    s_waitcnt vmcnt(20)
    ds_write_b32 v21, v20
    global_load_lds_dwordx4 v8, s[6:7] nt
    s_add_u32 m0, m0, s36
    s_nop 0
    global_load_lds_dwordx4 v9, s[6:7] nt
    s_add_u32 m0, m0, s36
    s_nop 0
    global_load_lds_dwordx4 v10, s[6:7] nt
    s_add_u32 m0, m0, s36
    s_nop 0
    global_load_lds_dwordx4 v11, s[6:7] nt
    s_add_u32 m0, m0, s36
    s_nop 0
    v_mov_b32 v20, 44
    s_waitcnt vmcnt(20)
    ds_write_b32 v21, v20
    global_load_lds_dwordx4 v12, s[8:9] nt
    s_add_u32 m0, m0, s36
    v_xor_b32 v12, 4096, v12
    global_load_lds_dwordx4 v13, s[8:9] nt
    s_add_u32 m0, m0, s36
    v_xor_b32 v13, 4096, v13
    global_load_lds_dwordx4 v18, s[8:9] nt
    s_add_u32 m0, m0, s36
    v_xor_b32 v18, 4096, v18
    global_load_lds_dwordx4 v19, s[8:9] nt
    s_add_u32 m0, m0, s36
    v_xor_b32 v19, 4096, v19
    s_add_u32 s8, s8, 0x20000
    s_addc_u32 s9, s9, 0
    v_mov_b32 v20, 48
    s_waitcnt vmcnt(20)
    ds_write_b32 v21, v20
    global_load_lds_dwordx4 v12, s[8:9] nt
    s_add_u32 m0, m0, s36
    v_xor_b32 v12, 12288, v12
    global_load_lds_dwordx4 v13, s[8:9] nt
    s_add_u32 m0, m0, s36
    v_xor_b32 v13, 12288, v13
    global_load_lds_dwordx4 v18, s[8:9] nt
    s_add_u32 m0, m0, s36
    v_xor_b32 v18, 12288, v18
    global_load_lds_dwordx4 v19, s[8:9] nt
    s_add_u32 m0, m0, s36
    v_xor_b32 v19, 12288, v19
    s_add_u32 s8, s8, 0x20000
    s_addc_u32 s9, s9, 0
    v_mov_b32 v20, 52
    s_waitcnt vmcnt(20)
    ds_write_b32 v21, v20
    global_load_lds_dwordx4 v12, s[8:9] nt
    s_add_u32 m0, m0, s36
    v_xor_b32 v12, 4096, v12
    global_load_lds_dwordx4 v13, s[8:9] nt
    s_add_u32 m0, m0, s36
    v_xor_b32 v13, 4096, v13
    global_load_lds_dwordx4 v18, s[8:9] nt
    s_add_u32 m0, m0, s36
    v_xor_b32 v18, 4096, v18
    global_load_lds_dwordx4 v19, s[8:9] nt
    s_add_u32 m0, m0, s36
    v_xor_b32 v19, 4096, v19
    s_add_u32 s8, s8, 0x20000
    s_addc_u32 s9, s9, 0
    v_mov_b32 v20, 56
    s_waitcnt vmcnt(20)
    ds_write_b32 v21, v20
    global_load_lds_dwordx4 v12, s[8:9] nt
    s_add_u32 m0, m0, s36
    v_xor_b32 v12, 28672, v12
    global_load_lds_dwordx4 v13, s[8:9] nt
    s_add_u32 m0, m0, s36
    v_xor_b32 v13, 28672, v13
    global_load_lds_dwordx4 v18, s[8:9] nt
    s_add_u32 m0, m0, s36
    v_xor_b32 v18, 28672, v18
    global_load_lds_dwordx4 v19, s[8:9] nt
    s_add_u32 m0, m0, s36
    v_xor_b32 v19, 28672, v19
    s_add_u32 s8, s8, 0x20000
    s_addc_u32 s9, s9, 0
    v_mov_b32 v20, 60
    s_waitcnt vmcnt(20)
    ds_write_b32 v21, v20
    global_load_lds_dwordx4 v12, s[8:9] nt
    s_add_u32 m0, m0, s36
    v_xor_b32 v12, 4096, v12
    global_load_lds_dwordx4 v13, s[8:9] nt
    s_add_u32 m0, m0, s36
    v_xor_b32 v13, 4096, v13
    global_load_lds_dwordx4 v18, s[8:9] nt
    s_add_u32 m0, m0, s36
    v_xor_b32 v18, 4096, v18
    global_load_lds_dwordx4 v19, s[8:9] nt
    s_add_u32 m0, m0, s36
    v_xor_b32 v19, 4096, v19
    s_add_u32 s8, s8, 0x20000
    s_addc_u32 s9, s9, 0
    v_mov_b32 v20, 64
    s_waitcnt vmcnt(20)
    ds_write_b32 v21, v20
    global_load_lds_dwordx4 v12, s[8:9] nt
    s_add_u32 m0, m0, s36
    v_xor_b32 v12, 12288, v12
    global_load_lds_dwordx4 v13, s[8:9] nt
    s_add_u32 m0, m0, s36
    v_xor_b32 v13, 12288, v13
    global_load_lds_dwordx4 v18, s[8:9] nt
    s_add_u32 m0, m0, s36
    v_xor_b32 v18, 12288, v18
    global_load_lds_dwordx4 v19, s[8:9] nt
    s_add_u32 m0, m0, s36
    v_xor_b32 v19, 12288, v19
    s_add_u32 s8, s8, 0x20000
    s_addc_u32 s9, s9, 0
    v_mov_b32 v20, 68
    s_waitcnt vmcnt(20)
    ds_write_b32 v21, v20
    global_load_lds_dwordx4 v12, s[8:9] nt
    s_add_u32 m0, m0, s36
    v_xor_b32 v12, 4096, v12
    global_load_lds_dwordx4 v13, s[8:9] nt
    s_add_u32 m0, m0, s36
    v_xor_b32 v13, 4096, v13
    global_load_lds_dwordx4 v18, s[8:9] nt
    s_add_u32 m0, m0, s36
    v_xor_b32 v18, 4096, v18
    global_load_lds_dwordx4 v19, s[8:9] nt
    s_add_u32 m0, m0, s36
    v_xor_b32 v19, 4096, v19
    s_add_u32 s8, s8, 0x20000
    s_addc_u32 s9, s9, 0
    v_mov_b32 v20, 72
    s_waitcnt vmcnt(20)
    ds_write_b32 v21, v20
    global_load_lds_dwordx4 v12, s[8:9] nt
    s_add_u32 m0, m0, s36
    s_nop 0
    global_load_lds_dwordx4 v13, s[8:9] nt
    s_add_u32 m0, m0, s36
    s_nop 0
    global_load_lds_dwordx4 v18, s[8:9] nt
    s_add_u32 m0, m0, s36
    s_nop 0
    global_load_lds_dwordx4 v19, s[8:9] nt
    s_add_u32 m0, m0, s36
    s_nop 0
    v_mov_b32 v20, 76
    s_waitcnt vmcnt(20)
    ds_write_b32 v21, v20
    global_load_lds_dwordx4 v15, s[12:13] nt
    s_add_u32 m0, m0, s36
    v_add_u32 v15, s44, v15
    global_load_lds_dwordx4 v15, s[12:13] nt
    s_add_u32 m0, m0, s36
    v_add_u32 v15, s45, v15
    global_load_lds_dwordx4 v15, s[12:13] nt
    s_add_u32 m0, m0, s36
    v_add_u32 v15, s44, v15
    global_load_lds_dwordx4 v15, s[12:13] nt
    s_add_u32 m0, m0, s36
    v_add_u32 v15, s46, v15
    v_mov_b32 v20, 80
    s_waitcnt vmcnt(20)
    ds_write_b32 v21, v20
    global_load_lds_dwordx4 v15, s[12:13] nt
    s_add_u32 m0, m0, s36
    v_add_u32 v15, s44, v15
    global_load_lds_dwordx4 v15, s[12:13] nt
    s_add_u32 m0, m0, s36
    v_add_u32 v15, s45, v15
    global_load_lds_dwordx4 v15, s[12:13] nt
    s_add_u32 m0, m0, s36
    v_add_u32 v15, s44, v15
    global_load_lds_dwordx4 v15, s[12:13] nt
    s_add_u32 m0, m0, s36
    v_add_u32 v15, s46, v15
    v_mov_b32 v20, 84
    s_waitcnt vmcnt(20)
    ds_write_b32 v21, v20
    global_load_lds_dwordx4 v15, s[12:13] nt
    s_add_u32 m0, m0, s36
    v_add_u32 v15, s44, v15
    global_load_lds_dwordx4 v15, s[12:13] nt
    s_add_u32 m0, m0, s36
    v_add_u32 v15, s45, v15
    global_load_lds_dwordx4 v15, s[12:13] nt
    s_add_u32 m0, m0, s36
    v_add_u32 v15, s44, v15
    global_load_lds_dwordx4 v15, s[12:13] nt
    s_add_u32 m0, m0, s36
    v_add_u32 v15, s46, v15
    v_mov_b32 v20, 88
    s_waitcnt vmcnt(20)
    ds_write_b32 v21, v20
    v_mov_b32 v20, 92
    s_waitcnt vmcnt(16)
    ds_write_b32 v21, v20
    v_mov_b32 v20, 96
    s_waitcnt vmcnt(12)
    ds_write_b32 v21, v20
    v_mov_b32 v40, 122880
L_g32:
    ds_read_b128 v[44:47], v40 offset:288
    s_sub_u32 s63, s63, 1
    s_cbranch_scc1 L_end
    s_waitcnt lgkmcnt(0)
    v_and_b32 v44, v44, v45
    v_and_b32 v46, v46, v47
    v_and_b32 v44, v44, v46
    v_cmp_eq_u32 vcc, 0, v44
    s_cbranch_vccnz L_g32
    global_load_lds_dwordx4 v15, s[12:13] nt
    s_add_u32 m0, m0, s36
    v_add_u32 v15, s44, v15
    global_load_lds_dwordx4 v15, s[12:13] nt
    s_add_u32 m0, m0, s36
    v_add_u32 v15, s45, v15
    global_load_lds_dwordx4 v15, s[12:13] nt
    s_add_u32 m0, m0, s36
    v_add_u32 v15, s44, v15
    global_load_lds_dwordx4 v15, s[12:13] nt
    s_add_u32 m0, m0, s36
    v_add_u32 v15, s46, v15
    global_load_lds_dwordx4 v16, s[20:21] nt
    s_add_u32 m0, m0, s36
    v_add_u32 v16, s39, v16
    global_load_lds_dwordx4 v16, s[20:21] nt
    s_add_u32 m0, m0, s36
    v_add_u32 v16, s39, v16
    global_load_lds_dwordx4 v16, s[20:21] nt
    s_add_u32 m0, m0, s36
    v_add_u32 v16, s39, v16
    global_load_lds_dwordx4 v16, s[20:21] nt
    s_add_u32 m0, m0, s36
    v_add_u32 v16, s39, v16
    global_load_lds_dwordx4 v16, s[20:21] nt
    s_add_u32 m0, m0, s36
    v_add_u32 v16, s39, v16
    global_load_lds_dwordx4 v16, s[20:21] nt
    s_add_u32 m0, m0, s36
    v_add_u32 v16, s39, v16
    global_load_lds_dwordx4 v16, s[20:21] nt
    s_add_u32 m0, m0, s36
    v_add_u32 v16, s39, v16
    global_load_lds_dwordx4 v16, s[20:21] nt
    s_add_u32 m0, m0, s36
    v_add_u32 v16, s39, v16
    v_mov_b32 v20, 100
    s_waitcnt vmcnt(20)
    ds_write_b32 v21, v20
    v_mov_b32 v20, 104
    s_waitcnt vmcnt(16)
    ds_write_b32 v21, v20
    v_mov_b32 v20, 108
    s_waitcnt vmcnt(12)
    ds_write_b32 v21, v20
L_join:
    s_lshl_b32 s32, s29, 14
    s_lshl_b32 s33, s30, 10
    s_add_u32 s32, s32, s33
    s_add_u32 s32, s32, 1048576
    v_lshrrev_b32 v22, 1, v0
    v_and_b32 v23, 1, v0
    v_lshlrev_b32 v24, 3, v23
    v_add_u32 v24, s32, v24
    v_lshl_add_u32 v25, v22, 4, v24
    v_min_u32 v26, 27, v22
    v_lshl_add_u32 v26, v26, 4, v24
    v_add_u32 v26, 512, v26
    s_lshl_b32 s32, s29, 7
    s_lshl_b32 s33, s30, 3
    s_add_u32 s32, s32, s33
    v_lshrrev_b32 v27, 5, v0
    v_lshl_add_u32 v27, v23, 1, v27
    v_lshlrev_b32 v27, 1, v27
    v_add_u32 v27, s32, v27
    v_cmp_gt_u32 vcc, 28, v22
    s_nop 1
    v_cndmask_b32 v30, 0, 1.0, vcc
    s_mul_i32 s56, s31, 0x9E3779B1
    s_add_u32 s56, s56, 0x7F4A7C15
    s_or_b32 s56, s56, 0x01010101
    s_cmp_eq_u32 s56, s31
    s_cselect_b32 s31, 2, 0
    s_xor_b32 s31, s31, s56
    s_and_b32 s56, s31, 0xff
    s_bfe_u32 s57, s31, 0x80008
    s_bfe_u32 s58, s31, 0x80010
    s_lshr_b32 s59, s31, 24
    v_mov_b32 v20, 112
    s_waitcnt vmcnt(8)
    ds_write_b32 v21, v20
    v_mov_b32 v20, 116
    s_waitcnt vmcnt(4)
    ds_write_b32 v21, v20
    v_mov_b32 v20, 120
    s_waitcnt vmcnt(0)
    ds_write_b32 v21, v20
    s_cmp_ge_u32 s30, 16
    s_cbranch_scc1 L_fin
    global_load_ushort v28, v27, s[4:5]
    v_lshlrev_b32 v22, 4, v23
    v_lshrrev_b32 v22, v22, s31
    v_and_b32 v23, 0xff, v22
    v_bfe_u32 v22, v22, 8, 8
L_f33:
    global_load_dwordx2 v[32:33], v26, s[26:27] sc1
    s_sub_u32 s63, s63, 1
    s_cbranch_scc1 L_end
    s_waitcnt vmcnt(0)
    v_xor_b32 v32, v23, v32
    v_xor_b32 v33, v22, v33
    v_or_b32 v31, v32, v33
    v_and_b32 v31, 0xff, v31
    v_cmp_ne_u32 vcc, 0, v31
    s_cbranch_vccnz L_f33
    global_load_dwordx2 v[48:49], v25, s[26:27] sc1
    v_mul_f32 v32, v32, v30
    v_mul_f32 v33, v33, v30
    s_nop 1
    v_permlane32_swap_b32 v32, v33
    v_add_f32 v32, v32, v33
    s_nop 1
    v_add_f32_dpp v32, v32, v32 row_ror:2 row_mask:0xf bank_mask:0xf
    s_nop 1
    v_add_f32_dpp v32, v32, v32 row_ror:4 row_mask:0xf bank_mask:0xf
    s_nop 1
    v_add_f32_dpp v32, v32, v32 row_ror:8 row_mask:0xf bank_mask:0xf
    v_mov_b32 v33, v32
    s_nop 1
    v_permlane16_swap_b32 v33, v32
    v_add_f32 v32, v33, v32
    v_cvt_pk_bf16_f32 v36, v32, v32
    v_and_b32 v36, 0xffff0000, v36
    v_mul_f32 v37, 0xbfb8aa3b, v36
    v_exp_f32 v37, v37
    v_lshlrev_b32 v28, 16, v28
    v_add_f32 v37, 1.0, v37
    v_rcp_f32 v37, v37
    s_nop 0
    v_mul_f32 v36, v36, v37
    v_cvt_pk_bf16_f32 v36, v36, v36
    v_and_b32 v36, 0xffff0000, v36
L_f34:
    global_load_dwordx2 v[50:51], v25, s[26:27] sc1
    s_sub_u32 s63, s63, 1
    s_cbranch_scc1 L_end
    s_waitcnt vmcnt(1)
    v_xor_b32 v38, v23, v48
    v_xor_b32 v39, v22, v49
    v_or_b32 v31, v38, v39
    v_and_b32 v31, 0xff, v31
    v_cmp_ne_u32 vcc, 0, v31
    s_cbranch_vccz L_fa35
    global_load_dwordx2 v[48:49], v25, s[26:27] sc1
    s_waitcnt vmcnt(1)
    v_xor_b32 v38, v23, v50
    v_xor_b32 v39, v22, v51
    v_or_b32 v31, v38, v39
    v_and_b32 v31, 0xff, v31
    v_cmp_ne_u32 vcc, 0, v31
    s_cbranch_vccnz L_f34
L_fa35:
    v_permlane32_swap_b32 v38, v39
    v_add_f32 v38, v38, v39
    s_nop 1
    v_add_f32_dpp v38, v38, v38 row_ror:2 row_mask:0xf bank_mask:0xf
    s_nop 1
    v_add_f32_dpp v38, v38, v38 row_ror:4 row_mask:0xf bank_mask:0xf
    s_nop 1
    v_add_f32_dpp v38, v38, v38 row_ror:8 row_mask:0xf bank_mask:0xf
    v_mov_b32 v39, v38
    s_nop 1
    v_permlane16_swap_b32 v39, v38
    v_add_f32 v38, v39, v38
    v_cvt_pk_bf16_f32 v38, v38, v38
    v_and_b32 v38, 0xffff0000, v38
    s_mov_b32 exec_lo, 3
    v_mul_f32 v38, v38, v36
    v_cvt_pk_bf16_f32 v38, v38, v38
    v_and_b32 v38, 0xffff0000, v38
    v_add_f32 v38, v28, v38
    v_cvt_pk_bf16_f32 v38, v38, v38
    s_mov_b32 exec_hi, 3
    global_store_short v27, v38, s[22:23]
    s_cmp_lg_u32 s2, 0
    s_cbranch_scc1 L_fin
    s_mov_b64 exec, 1
    v_mov_b32 v41, 0
    v_mov_b32 v42, s31
    global_store_dword v41, v42, s[26:27] sc1
L_fin:
    s_endpgm
L_A:
    s_sub_u32 s28, s28, 2
    v_lshlrev_b32 v8, 2, v0
    v_add_u32 v8, 122880, v8
    s_cmp_lg_u32 s28, 1
    s_cbranch_scc1 L_A1
    v_mov_b32 v4, 0
    v_cmp_lt_u32 vcc, 15, v0
    s_nop 1
    v_cndmask_b32 v5, 0, -1, vcc
    ds_write_b32 v8, v4
    ds_write_b32 v8, v5 offset:0x100
    s_waitcnt lgkmcnt(0)
L_A1:
    s_barrier
    v_and_b32 v2, 15, v0
    v_lshrrev_b32 v9, 2, v2
    s_lshl_b32 s32, s28, 13
    s_add_u32 s32, s32, 32768
    v_xor_b32 v10, v3, v2
    v_lshlrev_b32 v10, 4, v10
    v_lshl_add_u32 v10, v2, 8, v10
    v_add_u32 v10, s32, v10
    v_xor_b32 v11, 64, v10
    v_xor_b32 v12, 0x80, v10
    v_xor_b32 v13, 0xc0, v10
    s_waitcnt lgkmcnt(0)
    s_load_dword s31, s[26:27], 0
    v_mul_u32_u24 v14, 272, v9
    v_lshl_add_u32 v14, v3, 4, v14
    v_add_u32 v14, 124928, v14
    s_mul_i32 s32, s28, 272
    s_add_u32 s32, s32, 124928
    v_and_b32 v15, 31, v0
    v_lshlrev_b32 v15, 3, v15
    v_lshrrev_b32 v4, 5, v0
    v_lshl_add_u32 v15, v4, 2, v15
    v_add_u32 v15, s32, v15
    v_mov_b32 v16, 122880
    s_lshl_b32 s33, s28, 2
    s_add_u32 s33, s33, 122880
    v_mov_b32 v17, s33
    v_lshl_add_u32 v19, v9, 4, v17
    v_lshl_add_u32 v20, v3, 4, v16
    v_lshlrev_b32 v21, 6, v9
    v_lshl_add_u32 v21, v3, 4, v21
    v_add_u32 v21, 126976, v21
    v_and_b32 v4, 3, v0
    v_lshl_add_u32 v22, v4, 2, v21
    s_lshl_b32 s32, s28, 8
    v_add_u32 v22, s32, v22
    s_mov_b32 s52, 0xaaaaaaaa
    s_mov_b32 s53, s52
    s_mov_b32 s54, 0xcccccccc
    s_mov_b32 s55, s54
    v_mov_b32 v116, 0x3f803f80
    v_mov_b32 v117, v116
    v_mov_b32 v118, v116
    v_mov_b32 v119, v116
    v_bfe_u32 v5, v0, 2, 2
    v_lshl_add_u32 v5, v3, 2, v5
    v_lshlrev_b32 v6, 3, v4
    v_and_b32 v7, 7, v5
    s_lshl_b32 s32, s28, 1
    v_xor_b32 v7, s32, v7
    v_lshl_add_u32 v7, v7, 5, v6
    v_lshl_add_u32 v23, v5, 8, v7
    v_add_u32 v23, 65536, v23
    v_xor_b32 v24, 32, v23
    s_lshl_b32 s33, s28, 12
    v_bfe_u32 v7, v5, 1, 2
    v_xor_b32 v7, s28, v7
    v_lshl_add_u32 v7, v7, 5, v6
    v_lshl_add_u32 v25, v5, 7, v7
    v_add_u32 v25, 98304, v25
    s_lshl_b32 s32, s29, 13
    s_lshl_b32 s34, s28, 11
    s_add_u32 s32, s32, s34
    s_add_u32 s32, s32, 393216
    v_lshl_add_u32 v26, v0, 4, s32
    s_lshl_b32 s32, s29, 16
    s_add_u32 s32, s32, s33
    s_lshl_b32 s34, s30, 7
    s_add_u32 s32, s32, s34
    s_add_u32 s32, s32, 524288
    v_lshlrev_b32 v27, 3, v2
    v_lshl_add_u32 v27, v3, 14, v27
    v_add_u32 v27, s32, v27
    s_lshl_b32 s32, s30, 14
    s_add_u32 s32, s32, s33
    s_add_u32 s32, s32, 524288
    v_lshl_add_u32 v28, v0, 4, s32
    s_lshl_b32 s32, s29, 14
    s_lshl_b32 s33, s30, 4
    s_add_u32 s32, s32, s33
    s_lshl_b32 s33, s28, 12
    s_add_u32 s32, s32, s33
    s_add_u32 s32, s32, 1048576
    v_lshlrev_b32 v29, 2, v4
    v_lshl_add_u32 v29, v9, 10, v29
    v_add_u32 v29, s32, v29
    v_bfe_u32 v5, v0, 1, 2
    v_lshrrev_b32 v6, 5, v0
    v_lshlrev_b32 v6, 1, v6
    v_xor_b32 v5, v5, v6
    v_lshlrev_b32 v5, 4, v5
    v_and_b32 v6, 1, v0
    v_lshl_add_u32 v5, v6, 3, v5
    v_lshl_add_u32 v5, v3, 8, v5
    v_bfe_u32 v6, v0, 3, 1
    v_lshl_add_u32 v5, v6, 10, v5
    s_lshl_b32 s32, s28, 11
    s_add_u32 s32, s32, 131072
    v_add_u32 v30, s32, v5
    v_lshrrev_b32 v5, 3, v2
    v_lshlrev_b32 v5, 1, v5
    v_xor_b32 v5, v3, v5
    v_lshlrev_b32 v5, 4, v5
    v_lshl_add_u32 v5, v2, 6, v5
    v_add_u32 v31, 131072, v5
    s_lshl_b32 s32, s29, 8
    s_add_u32 s32, s32, 4096
    v_and_b32 v5, 31, v0
    v_lshl_add_u32 v104, v5, 3, s32
    s_waitcnt lgkmcnt(0)
    s_mul_i32 s56, s31, 0x9E3779B1
    s_add_u32 s56, s56, 0x7F4A7C15
    s_or_b32 s56, s56, 0x01010101
    s_cmp_eq_u32 s56, s31
    s_cselect_b32 s31, 2, 0
    s_xor_b32 s31, s31, s56
    s_and_b32 s56, s31, 0xff
    s_bfe_u32 s57, s31, 0x80008
    s_bfe_u32 s58, s31, 0x80010
    s_lshr_b32 s59, s31, 24
    v_and_b32 v113, 3, v0
    v_lshlrev_b32 v113, 3, v113
    v_lshrrev_b32 v113, v113, s31
    s_movk_i32 s60, 0xff00
    s_cmp_lg_u32 s28, 3
    s_cbranch_scc1 L_A2
    s_getreg_b32 s33, hwreg(HW_REG_XCC_ID)
    s_lshl_b32 s34, s30, 3
    s_add_u32 s32, s32, s34
    v_mov_b32 v4, s32
    v_mov_b32 v6, s33
    v_mov_b32 v7, s31
    s_mov_b64 exec, 1
    global_store_dwordx2 v4, v[6:7], s[26:27] sc1
    s_mov_b64 exec, -1
L_A2:
    s_mov_b32 s34, 0x3db504f3
    s_mov_b32 s35, 0x3fb8aa3b
    s_lshl_b32 s47, s29, 2
    s_lshr_b32 s47, 0x44444444, s47
    s_and_b32 s47, s47, 15
    s_mov_b32 s32, 40
    s_cmp_ge_u32 s62, s32
    s_cbranch_scc1 L_wd39
L_wl38:
    ds_read_b32 v4, v8
    s_waitcnt lgkmcnt(0)
    v_readfirstlane_b32 s62, v4
    s_cmp_ge_u32 s62, s32
    s_cbranch_scc1 L_wd39
    s_sleep 1
    s_sub_u32 s63, s63, 1
    s_cbranch_scc1 L_end
    s_branch L_wl38
L_wd39:
    global_load_dwordx4 v[88:91], v26, s[26:27] offset:0 sc1
    global_load_dwordx4 v[92:95], v26, s[26:27] offset:1024 sc1
    s_setprio 2
    s_lshl_b32 s32, s28, 3
    s_add_u32 s32, s32, 40
    s_cmp_ge_u32 s62, s32
    s_cbranch_scc1 L_wd43
L_wl42:
    ds_read_b32 v4, v8
    s_waitcnt lgkmcnt(0)
    v_readfirstlane_b32 s62, v4
    s_cmp_ge_u32 s62, s32
    s_cbranch_scc1 L_wd43
    s_sleep 1
    s_sub_u32 s63, s63, 1
    s_cbranch_scc1 L_end
    s_branch L_wl42
L_wd43:
    ds_read_b128 v[32:35], v10 offset:0
    ds_read_b128 v[36:39], v11 offset:0
    ds_read_b128 v[40:43], v12 offset:0
    ds_read_b128 v[44:47], v13 offset:0
    ds_read_b128 v[48:51], v10 offset:4096
    ds_read_b128 v[52:55], v11 offset:4096
    ds_read_b128 v[56:59], v12 offset:4096
    ds_read_b128 v[60:63], v13 offset:4096
    s_branch L_h1a41
L_h140:
    v_xor_b32 v26, 131072, v26
    global_load_dwordx4 v[88:91], v26, s[26:27] offset:0 sc1
    global_load_dwordx4 v[92:95], v26, s[26:27] offset:1024 sc1
    s_sub_u32 s63, s63, 1
    s_cbranch_scc1 L_end
L_h1a41:
    s_waitcnt vmcnt(0)
    v_xor_b32 v88, s56, v88
    v_xor_b32 v89, s57, v89
    v_xor_b32 v90, s58, v90
    v_xor_b32 v91, s59, v91
    v_xor_b32 v92, s56, v92
    v_xor_b32 v93, s57, v93
    v_xor_b32 v94, s58, v94
    v_xor_b32 v95, s59, v95
    v_or3_b32 v4, v88, v89, v90
    v_or3_b32 v4, v4, v91, v92
    v_or3_b32 v4, v4, v93, v94
    v_or_b32 v4, v4, v95
    v_and_b32 v4, 0xff, v4
    v_cmp_ne_u32 vcc, 0, v4
    s_mov_b64 exec, vcc
    s_cbranch_execnz L_h140
    s_mov_b64 exec, -1
    v_add_f32 v88, v88, v92
    v_add_f32 v89, v89, v93
    v_add_f32 v90, v90, v94
    v_add_f32 v91, v91, v95
    s_nop 0
    v_permlane32_swap_b32 v88, v90
    v_permlane32_swap_b32 v89, v91
    v_add_f32 v88, v88, v90
    v_add_f32 v89, v89, v91
    v_cvt_pk_bf16_f32 v88, v88, v89
    v_mov_b32 v89, 1
    ds_write_b32 v15, v88
    ds_write_b32 v17, v89 offset:256
    global_load_dwordx2 v[106:107], v104, s[26:27] sc1
L_sa44:
    ds_read_b128 v[4:7], v16 offset:256
    ds_read_b128 v[64:67], v14 offset:0
    ds_read_b128 v[68:71], v14 offset:64
    ds_read_b128 v[72:75], v14 offset:128
    ds_read_b128 v[76:79], v14 offset:192
    s_sub_u32 s63, s63, 1
    s_cbranch_scc1 L_end
    s_waitcnt lgkmcnt(0)
    v_and_b32 v4, v4, v5
    v_and_b32 v6, v6, v7
    v_and_b32 v4, v4, v6
    v_cmp_eq_u32 vcc, 0, v4
    s_cbranch_vccnz L_sa44
    v_mfma_f32_16x16x32_bf16 v[80:83], v[32:35], v[64:67], 0
    v_mfma_f32_16x16x32_bf16 v[84:87], v[48:51], v[64:67], 0
    v_mfma_f32_16x16x32_bf16 v[80:83], v[36:39], v[68:71], v[80:83]
    v_mfma_f32_16x16x32_bf16 v[84:87], v[52:55], v[68:71], v[84:87]
    v_mfma_f32_16x16x32_bf16 v[80:83], v[40:43], v[72:75], v[80:83]
    v_mfma_f32_16x16x32_bf16 v[84:87], v[56:59], v[72:75], v[84:87]
    v_mfma_f32_16x16x32_bf16 v[80:83], v[44:47], v[76:79], v[80:83]
    v_mfma_f32_16x16x32_bf16 v[84:87], v[60:63], v[76:79], v[84:87]
    s_nop 6
    v_cvt_pk_bf16_f32 v88, v80, v81
    v_cvt_pk_bf16_f32 v89, v82, v83
    v_cvt_pk_bf16_f32 v90, v84, v85
    v_cvt_pk_bf16_f32 v91, v86, v87
    v_cndmask_b32 v88, v88, v89, s[52:53]
    v_cndmask_b32 v90, v90, v91, s[52:53]
    v_cndmask_b32 v88, v88, v90, s[54:55]
    v_lshlrev_b32 v80, 16, v88
    v_and_b32 v81, 0xffff0000, v88
    v_mul_f32 v80, s34, v80
    v_mul_f32 v81, s34, v81
    v_cvt_pk_bf16_f32 v88, v80, v81
    v_lshlrev_b32 v80, 16, v88
    v_and_b32 v81, 0xffff0000, v88
    v_max_f32 v4, v80, v81
    s_nop 1
    v_max_f32_dpp v4, v4, v4 quad_perm:[1,0,3,2] row_mask:0xf bank_mask:0xf
    s_nop 1
    v_max_f32_dpp v4, v4, v4 quad_perm:[2,3,0,1] row_mask:0xf bank_mask:0xf
    v_mov_b32 v5, v4
    s_nop 1
    v_permlane16_swap_b32 v5, v4
    v_max_f32 v4, v5, v4
    v_mov_b32 v5, v4
    s_nop 1
    v_permlane32_swap_b32 v5, v4
    v_max_f32 v4, v5, v4
    v_mul_f32 v4, s35, v4
    v_fma_f32 v80, v80, s35, -v4
    v_fma_f32 v81, v81, s35, -v4
    v_exp_f32 v80, v80
    v_exp_f32 v81, v81
    s_nop 0
    v_cvt_pk_bf16_f32 v88, v80, v81
    ds_write_b32 v22, v88
    ds_write_b32 v19, v4 offset:320
    ds_read_b32 v97, v8
    ds_read_b64_tr_b16 v[48:49], v23 offset:0
    ds_read_b64_tr_b16 v[50:51], v23 offset:4096
    ds_read_b64_tr_b16 v[52:53], v24 offset:0
    ds_read_b64_tr_b16 v[54:55], v24 offset:4096
    ds_read_b64_tr_b16 v[56:57], v23 offset:8192
    ds_read_b64_tr_b16 v[58:59], v23 offset:12288
    ds_read_b64_tr_b16 v[60:61], v24 offset:8192
    ds_read_b64_tr_b16 v[62:63], v24 offset:12288
    ds_read_b64_tr_b16 v[64:65], v23 offset:16384
    ds_read_b64_tr_b16 v[66:67], v23 offset:20480
    ds_read_b64_tr_b16 v[68:69], v24 offset:16384
    ds_read_b64_tr_b16 v[70:71], v24 offset:20480
    ds_read_b64_tr_b16 v[72:73], v23 offset:24576
    ds_read_b64_tr_b16 v[74:75], v23 offset:28672
    ds_read_b64_tr_b16 v[76:77], v24 offset:24576
    ds_read_b64_tr_b16 v[78:79], v24 offset:28672
L_sc45:
    ds_read_b128 v[4:7], v20 offset:320
    ds_read_b128 v[32:35], v21 offset:0
    ds_read_b128 v[36:39], v21 offset:256
    ds_read_b128 v[40:43], v21 offset:512
    ds_read_b128 v[44:47], v21 offset:768
    s_sub_u32 s63, s63, 1
    s_cbranch_scc1 L_end
    s_waitcnt lgkmcnt(0)
    v_max3_u32 v88, v4, v5, v6
    v_max_u32 v88, v88, v7
    v_cmp_eq_u32 vcc, -1, v88
    s_cbranch_vccnz L_sc45
    v_mfma_f32_16x16x32_bf16 v[152:155], v[32:35], v[116:119], 0
    v_max3_f32 v92, v4, v5, v6
    v_max_f32 v92, v92, v7
    v_sub_f32 v4, v4, v92
    v_mfma_f32_16x16x32_bf16 v[156:159], v[36:39], v[116:119], 0
    v_sub_f32 v5, v5, v92
    v_sub_f32 v6, v6, v92
    v_sub_f32 v7, v7, v92
    v_mfma_f32_16x16x32_bf16 v[160:163], v[40:43], v[116:119], 0
    v_exp_f32 v4, v4
    v_exp_f32 v5, v5
    v_exp_f32 v6, v6
    v_mfma_f32_16x16x32_bf16 v[164:167], v[44:47], v[116:119], 0
    v_exp_f32 v7, v7
    v_cmp_gt_u32 vcc, 96, v97
    s_cbranch_vccnz L_pvs46
    v_mfma_f32_16x16x32_bf16 v[120:123], v[32:35], v[48:51], 0
    v_mfma_f32_16x16x32_bf16 v[124:127], v[32:35], v[52:55], 0
    v_mfma_f32_16x16x32_bf16 v[128:131], v[36:39], v[56:59], 0
    v_mfma_f32_16x16x32_bf16 v[132:135], v[36:39], v[60:63], 0
    v_mul_f32 v93, v4, v152
    v_fmac_f32 v93, v5, v156
    v_fmac_f32 v93, v6, v160
    v_fmac_f32 v93, v7, v164
    v_mfma_f32_16x16x32_bf16 v[136:139], v[40:43], v[64:67], 0
    v_mfma_f32_16x16x32_bf16 v[140:143], v[40:43], v[68:71], 0
    v_rcp_f32 v96, v93
    v_log_f32 v94, v93
    v_mov_b32 v103, s31
    v_mul_f32 v4, v4, v96
    v_mfma_f32_16x16x32_bf16 v[144:147], v[44:47], v[72:75], 0
    v_mfma_f32_16x16x32_bf16 v[148:151], v[44:47], v[76:79], 0
    v_mul_f32 v5, v5, v96
    v_mul_f32 v6, v6, v96
    v_mul_f32 v7, v7, v96
    v_add_f32 v102, v92, v94
    v_mul_f32 v80, v4, v120
    v_mul_f32 v84, v4, v124
    v_fmac_f32 v80, v5, v128
    v_fmac_f32 v84, v5, v132
    v_fmac_f32 v80, v6, v136
    v_fmac_f32 v84, v6, v140
    v_fmac_f32 v80, v7, v144
    v_fmac_f32 v84, v7, v148
    s_branch L_pvd47
L_pvs46:
    s_nop 7
    v_mul_f32 v93, v4, v152
    v_fmac_f32 v93, v5, v156
    v_fmac_f32 v93, v6, v160
    v_fmac_f32 v93, v7, v164
    v_rcp_f32 v96, v93
    v_log_f32 v94, v93
    v_mov_b32 v103, s31
    v_mul_f32 v4, v4, v96
    v_mul_f32 v5, v5, v96
    v_mul_f32 v6, v6, v96
    v_mul_f32 v7, v7, v96
    v_add_f32 v102, v92, v94
    s_cmp_ge_u32 s62, 72
    s_cbranch_scc1 L_wd49
L_wl48:
    ds_read_b32 v97, v8
    s_waitcnt lgkmcnt(0)
    v_readfirstlane_b32 s62, v97
    s_cmp_ge_u32 s62, 72
    s_cbranch_scc1 L_wd49
    s_sleep 1
    s_sub_u32 s63, s63, 1
    s_cbranch_scc1 L_end
    s_branch L_wl48
L_wd49:
    ds_read_b64_tr_b16 v[48:49], v23 offset:0
    ds_read_b64_tr_b16 v[50:51], v23 offset:4096
    ds_read_b64_tr_b16 v[52:53], v24 offset:0
    ds_read_b64_tr_b16 v[54:55], v24 offset:4096
    s_waitcnt lgkmcnt(0)
    v_mfma_f32_16x16x32_bf16 v[120:123], v[32:35], v[48:51], 0
    v_mfma_f32_16x16x32_bf16 v[124:127], v[32:35], v[52:55], 0
    s_cmp_ge_u32 s62, 80
    s_cbranch_scc1 L_wd51
L_wl50:
    ds_read_b32 v97, v8
    s_waitcnt lgkmcnt(0)
    v_readfirstlane_b32 s62, v97
    s_cmp_ge_u32 s62, 80
    s_cbranch_scc1 L_wd51
    s_sub_u32 s63, s63, 1
    s_cbranch_scc1 L_end
    s_branch L_wl50
L_wd51:
    ds_read_b64_tr_b16 v[56:57], v23 offset:8192
    ds_read_b64_tr_b16 v[58:59], v23 offset:12288
    ds_read_b64_tr_b16 v[60:61], v24 offset:8192
    ds_read_b64_tr_b16 v[62:63], v24 offset:12288
    s_nop 3
    v_mul_f32 v80, v4, v120
    v_mul_f32 v84, v4, v124
    s_waitcnt lgkmcnt(0)
    v_mfma_f32_16x16x32_bf16 v[128:131], v[36:39], v[56:59], 0
    v_mfma_f32_16x16x32_bf16 v[132:135], v[36:39], v[60:63], 0
    s_cmp_ge_u32 s62, 88
    s_cbranch_scc1 L_wd53
L_wl52:
    ds_read_b32 v97, v8
    s_waitcnt lgkmcnt(0)
    v_readfirstlane_b32 s62, v97
    s_cmp_ge_u32 s62, 88
    s_cbranch_scc1 L_wd53
    s_sub_u32 s63, s63, 1
    s_cbranch_scc1 L_end
    s_branch L_wl52
L_wd53:
    ds_read_b64_tr_b16 v[48:49], v23 offset:16384
    ds_read_b64_tr_b16 v[50:51], v23 offset:20480
    ds_read_b64_tr_b16 v[52:53], v24 offset:16384
    ds_read_b64_tr_b16 v[54:55], v24 offset:20480
    s_nop 3
    v_fmac_f32 v80, v5, v128
    v_fmac_f32 v84, v5, v132
    s_waitcnt lgkmcnt(0)
    v_mfma_f32_16x16x32_bf16 v[136:139], v[40:43], v[48:51], 0
    v_mfma_f32_16x16x32_bf16 v[140:143], v[40:43], v[52:55], 0
    s_nop 7
    v_fmac_f32 v80, v6, v136
    v_fmac_f32 v84, v6, v140
L_vl54:
    ds_read_b32 v97, v8
    ds_read_b64_tr_b16 v[56:57], v23 offset:24576
    ds_read_b64_tr_b16 v[58:59], v23 offset:28672
    ds_read_b64_tr_b16 v[60:61], v24 offset:24576
    ds_read_b64_tr_b16 v[62:63], v24 offset:28672
    s_sub_u32 s63, s63, 1
    s_cbranch_scc1 L_end
    s_waitcnt lgkmcnt(0)
    v_cmp_gt_u32 vcc, 96, v97
    s_cbranch_vccnz L_vl54
    v_mfma_f32_16x16x32_bf16 v[144:147], v[44:47], v[56:59], 0
    v_mfma_f32_16x16x32_bf16 v[148:151], v[44:47], v[60:63], 0
    s_nop 6
    v_fmac_f32 v80, v7, v144
    v_fmac_f32 v84, v7, v148
L_pvd47:
    v_cvt_pk_bf16_f32 v100, v80, v84
    v_mov_b32 v4, 1
    s_nop 0
    v_mov_b32_dpp v101, v100 quad_perm:[1,0,3,2] row_mask:0xf bank_mask:0xf
    s_mov_b32 exec_lo, 0x55555555
    s_mov_b32 exec_hi, 0x55555555
    global_store_dwordx4 v27, v[100:103], s[26:27] sc1
    s_mov_b64 exec, -1
    ds_write_b32 v17, v4 offset:288
    s_waitcnt vmcnt(1)
    s_branch L_xd56
L_xc55:
    global_load_dwordx2 v[106:107], v104, s[26:27] sc1
    s_sub_u32 s63, s63, 1
    s_cbranch_scc1 L_end
    s_waitcnt vmcnt(0)
L_xd56:
    v_cmp_ne_u32 vcc, s31, v107
    s_cbranch_vccnz L_xc55
    s_getreg_b32 s32, hwreg(HW_REG_XCC_ID)
    v_cmp_ne_u32 vcc, s32, v106
    s_cmp_eq_u64 vcc, 0
    s_cselect_b32 s61, 1, 0
    s_cmp_ge_u32 s62, 112
    s_cbranch_scc1 L_wd60
L_wl59:
    ds_read_b32 v4, v8
    s_waitcnt lgkmcnt(0)
    v_readfirstlane_b32 s62, v4
    s_cmp_ge_u32 s62, 112
    s_cbranch_scc1 L_wd60
    s_sub_u32 s63, s63, 1
    s_cbranch_scc1 L_end
    s_branch L_wl59
L_wd60:
    global_load_dwordx4 v[88:91], v28, s[26:27] offset:0 sc1
    global_load_dwordx4 v[92:95], v28, s[26:27] offset:1024 sc1
    global_load_dwordx4 v[96:99], v28, s[26:27] offset:2048 sc1
    global_load_dwordx4 v[100:103], v28, s[26:27] offset:3072 sc1
    ds_read_b64_tr_b16 v[64:65], v25 offset:0
    ds_read_b64_tr_b16 v[66:67], v25 offset:2048
    ds_read_b64_tr_b16 v[68:69], v25 offset:4096
    ds_read_b64_tr_b16 v[70:71], v25 offset:6144
    ds_read_b64_tr_b16 v[72:73], v25 offset:8192
    ds_read_b64_tr_b16 v[74:75], v25 offset:10240
    ds_read_b64_tr_b16 v[76:77], v25 offset:12288
    ds_read_b64_tr_b16 v[78:79], v25 offset:14336
    s_branch L_h2a58
L_h257:
    global_load_dwordx4 v[88:91], v28, s[26:27] offset:0 sc1
    global_load_dwordx4 v[92:95], v28, s[26:27] offset:1024 sc1
    global_load_dwordx4 v[96:99], v28, s[26:27] offset:2048 sc1
    global_load_dwordx4 v[100:103], v28, s[26:27] offset:3072 sc1
    s_sub_u32 s63, s63, 1
    s_cbranch_scc1 L_end
L_h2a58:
    v_mov_b32 v6, 1
    s_waitcnt vmcnt(0)
    v_xor_b32 v4, s31, v91
    v_bitop3_b32 v4, v95, s31, v4 bitop3:0xbe
    v_bitop3_b32 v4, v99, s31, v4 bitop3:0xbe
    v_bitop3_b32 v4, v103, s31, v4 bitop3:0xbe
    v_cmp_ne_u32 vcc, 0, v4
    s_mov_b64 exec, vcc
    s_cbranch_execnz L_h257
    s_mov_b64 exec, -1
    ds_write_b64 v30, v[88:89] offset:0
    ds_write_b64 v30, v[92:93] offset:64
    ds_write_b64 v30, v[96:97] offset:128
    ds_write_b64 v30, v[100:101] offset:192
    ds_write_b32 v17, v6 offset:272
    ds_read_b128 v[4:7], v16 offset:272
    ds_read_b128 v[32:35], v31 offset:0
    ds_read_b128 v[36:39], v31 offset:1024
    ds_read_b128 v[40:43], v31 offset:2048
    ds_read_b128 v[44:47], v31 offset:3072
    ds_read_b128 v[48:51], v31 offset:4096
    ds_read_b128 v[52:55], v31 offset:5120
    ds_read_b128 v[56:59], v31 offset:6144
    ds_read_b128 v[60:63], v31 offset:7168
    v_max3_f32 v97, v90, v94, v98
    v_max_f32 v97, v97, v102
    s_nop 1
    v_max_f32_dpp v97, v97, v97 row_ror:8 row_mask:0xf bank_mask:0xf
    v_mov_b32 v96, v97
    s_nop 1
    v_permlane16_swap_b32 v96, v97
    v_max_f32 v97, v96, v97
    v_mov_b32 v96, v97
    s_nop 1
    v_permlane32_swap_b32 v96, v97
    v_max_f32 v97, v96, v97
    v_sub_f32 v104, v90, v97
    v_sub_f32 v105, v94, v97
    v_sub_f32 v106, v98, v97
    v_sub_f32 v107, v102, v97
    v_exp_f32 v104, v104
    v_exp_f32 v105, v105
    v_exp_f32 v106, v106
    v_exp_f32 v107, v107
    s_branch L_sda62
L_sd61:
    ds_read_b128 v[4:7], v16 offset:272
    ds_read_b128 v[32:35], v31 offset:0
    ds_read_b128 v[36:39], v31 offset:1024
    ds_read_b128 v[40:43], v31 offset:2048
    ds_read_b128 v[44:47], v31 offset:3072
    ds_read_b128 v[48:51], v31 offset:4096
    ds_read_b128 v[52:55], v31 offset:5120
    ds_read_b128 v[56:59], v31 offset:6144
    ds_read_b128 v[60:63], v31 offset:7168
    s_sub_u32 s63, s63, 1
    s_cbranch_scc1 L_end
L_sda62:
    s_waitcnt lgkmcnt(8)
    v_and_b32 v4, v4, v5
    v_and_b32 v6, v6, v7
    v_and_b32 v4, v4, v6
    v_cmp_eq_u32 vcc, 0, v4
    s_cbranch_vccnz L_sd61
    s_waitcnt lgkmcnt(7)
    v_mfma_f32_16x16x32_bf16 v[80:83], v[32:35], v[64:67], 0
    v_add_f32 v96, v104, v105
    v_add_f32 v97, v106, v107
    v_add_f32 v96, v96, v97
    s_waitcnt lgkmcnt(6)
    v_mfma_f32_16x16x32_bf16 v[84:87], v[36:39], v[64:67], 0
    v_mov_b32 v108, v104
    v_mov_b32 v109, v105
    v_mov_b32 v110, v106
    s_waitcnt lgkmcnt(5)
    v_mfma_f32_16x16x32_bf16 v[80:83], v[40:43], v[68:71], v[80:83]
    v_mov_b32 v111, v107
    v_add_f32_dpp v96, v96, v96 row_ror:8 row_mask:0xf bank_mask:0xf
    v_mov_b32_dpp v108, v104 row_ror:8 row_mask:0xf bank_mask:0xc
    s_waitcnt lgkmcnt(4)
    v_mfma_f32_16x16x32_bf16 v[84:87], v[44:47], v[68:71], v[84:87]
    v_mov_b32_dpp v109, v105 row_ror:8 row_mask:0xf bank_mask:0xc
    v_mov_b32_dpp v110, v106 row_ror:8 row_mask:0xf bank_mask:0xc
    v_mov_b32_dpp v111, v107 row_ror:8 row_mask:0xf bank_mask:0xc
    s_waitcnt lgkmcnt(3)
    v_mfma_f32_16x16x32_bf16 v[80:83], v[48:51], v[72:75], v[80:83]
    v_mov_b32 v97, v96
    v_mov_b32_dpp v104, v104 row_ror:8 row_mask:0xf bank_mask:0x3
    v_mov_b32_dpp v105, v105 row_ror:8 row_mask:0xf bank_mask:0x3
    s_waitcnt lgkmcnt(2)
    v_mfma_f32_16x16x32_bf16 v[84:87], v[52:55], v[72:75], v[84:87]
    v_permlane16_swap_b32 v97, v96
    v_add_f32 v96, v97, v96
    v_mov_b32 v97, v96
    s_waitcnt lgkmcnt(1)
    v_mfma_f32_16x16x32_bf16 v[80:83], v[56:59], v[76:79], v[80:83]
    v_mov_b32_dpp v106, v106 row_ror:8 row_mask:0xf bank_mask:0x3
    v_mov_b32_dpp v107, v107 row_ror:8 row_mask:0xf bank_mask:0x3
    v_permlane32_swap_b32 v97, v96
    s_waitcnt lgkmcnt(0)
    v_mfma_f32_16x16x32_bf16 v[84:87], v[60:63], v[76:79], v[84:87]
    v_add_f32 v96, v97, v96
    v_rcp_f32 v96, v96
    s_nop 0
    v_mul_f32 v100, v108, v80
    s_nop 3
    v_mul_f32 v98, v104, v84
    v_fmac_f32 v100, v109, v81
    v_fmac_f32 v98, v105, v85
    v_fmac_f32 v100, v110, v82
    v_fmac_f32 v98, v106, v86
    v_fmac_f32 v100, v111, v83
    v_fmac_f32 v98, v107, v87
    v_add_f32 v100, v100, v98
    v_mov_b32 v98, v100
    s_nop 1
    v_permlane16_swap_b32 v98, v100
    v_add_f32 v100, v98, v100
    v_mov_b32 v98, v100
    s_nop 1
    v_permlane32_swap_b32 v98, v100
    v_add_f32 v100, v98, v100
    v_mul_f32 v100, v100, v96
    v_bfi_b32 v100, s60, v100, v113
    s_mov_b64 exec, 0xffff
    s_cmp_eq_u32 s61, 1
    s_cbranch_scc0 L_p363
    global_store_dword v29, v100, s[26:27]
    s_branch L_p3e64
L_p363:
    global_store_dword v29, v100, s[26:27] sc1
L_p3e64:
L_end:
    s_endpgm
.section .rodata,"a"
.p2align 6
.amdhsa_kernel recurrent_scan__sliding_block_cached__geglu_ffn__decode_kernel
  .amdhsa_next_free_vgpr 168
  .amdhsa_next_free_sgpr 96
  .amdhsa_accum_offset 168
  .amdhsa_group_segment_fixed_size 0
  .amdhsa_kernarg_size 96
  .amdhsa_user_sgpr_count 2
  .amdhsa_user_sgpr_kernarg_segment_ptr 1
  .amdhsa_system_sgpr_workgroup_id_x 1
.end_amdhsa_kernel
```
